```python
import torch

def _softmax(x, axis=-1):
    return torch.softmax(x, dim=axis)
def _gelu(x):
    return torch.nn.functional.gelu(x, approximate="tanh")
def _silu(x):
    return torch.nn.functional.silu(x)
def _sigmoid(x):
    return torch.sigmoid(x)
def _layernorm(x, axis=-1, eps=1e-5):
    m = x.mean(dim=axis, keepdim=True)
    v = x.var(dim=axis, keepdim=True, unbiased=False)
    return (x - m) / torch.sqrt(v + eps)
def _scatter_add(tgt, idx, src, axis=0):
    return tgt.clone().index_add_(axis, idx, src)
def _segment_sum(src, seg, n):
    out = torch.zeros((n,) + src.shape[1:], dtype=src.dtype)
    return out.index_add_(0, seg, src)
def _pad(x, pw):
    flat = tuple(v for pair in reversed(pw) for v in pair)
    return torch.nn.functional.pad(x, flat)

kernel_name = 'gated_mix__mha_block__geglu_ffn__prompt'

def setup_inputs():

    _w = (lambda a: (lambda t: t.to(torch.bfloat16) if t.is_floating_point() else t)(torch.as_tensor(a)))
    def _A_setup():
        B, S, D, H = 1, 2048, 1024, 32
        return {
            "x": _w((lambda *s: torch.randn(*s, dtype=torch.bfloat16) * 0.05)(B, S, D)),
            "wqkv": _w((lambda *s: torch.randn(*s, dtype=torch.bfloat16) * 0.8)(D, 3 * D)),
            "wo": _w((lambda *s: torch.randn(*s, dtype=torch.bfloat16) * 0.05)(D, D)),
        }
    _A_in = _A_setup()

    def _B_setup():
        B, S, D, F = 1, 2048, 1024, 3584
        return {
            "x": _w((lambda *s: torch.randn(*s, dtype=torch.bfloat16) * 0.05)(B, S, D)),
            "w_gate": _w((lambda *s: torch.randn(*s, dtype=torch.bfloat16) * 0.1)(D, F)),
            "w_up": _w((lambda *s: torch.randn(*s, dtype=torch.bfloat16) * 0.1)(D, F)),
            "w_down": _w((lambda *s: torch.randn(*s, dtype=torch.bfloat16) * 0.1)(F, D)),
        }
    _B_in = _B_setup()

    return {
        "A_x": _A_in["x"],
        "A_wqkv": _A_in["wqkv"],
        "A_wo": _A_in["wo"],
        "B_x": _B_in["x"],
        "B_w_gate": _B_in["w_gate"],
        "B_w_up": _B_in["w_up"],
        "B_w_down": _B_in["w_down"],
        "gate_w": _w((lambda *s: torch.randn(*s, dtype=torch.bfloat16) * 0.05)(1024) * 16.0),
    }

def reference(A_x, A_wqkv, A_wo, B_x, B_w_gate, B_w_up, B_w_down, gate_w):
    def _A_ref(x, wqkv, wo):
        B, S, D = x.shape
        H = 32
        Dh = D // H
        qkv = (lambda x, *d: x.permute(*d))((x @ wqkv).reshape(B, S, 3, H, Dh), 2, 0, 3, 1, 4)
        q, k, v = qkv[0], qkv[1], qkv[2]
        scores = torch.einsum("bhqd,bhkd->bhqk", q, k) * (Dh ** -0.5)
        p = _softmax(scores, axis=-1)
        o = torch.einsum("bhqk,bhkd->bhqd", p, v)
        return (lambda x, *d: x.permute(*d))(o, 0, 2, 1, 3).reshape(B, S, D) @ wo

    def _B_ref(x, w_gate, w_up, w_down):
        return (_gelu(x @ w_gate) * (x @ w_up)) @ w_down

    x = A_x
    g = _sigmoid((x * gate_w).sum(-1, keepdims=True))
    a = _A_ref(x, A_wqkv, A_wo)
    b = _B_ref(x, B_w_gate, B_w_up, B_w_down)
    return g * a + (1 - g) * b
```

```asm
; @launch kernel=l1_kernel grid=(256,1,1) block=(512,1,1) lds=147456
; @launch kernel=mid_kernel grid=(768,1,1) block=(256,1,1) lds=49152
; @launch kernel=wo_kernel grid=(256,1,1) block=(256,1,1) lds=73728
.amdgcn_target "amdgcn-amd-amdhsa--gfx950"
.text
.globl l1_kernel
.p2align 8
.type l1_kernel,@function
l1_kernel:
  s_cmp_ge_u32 s2, 256
  s_cbranch_scc1 L_l1_end
  s_load_dwordx16 s[4:19], s[0:1], 0
  s_load_dwordx4 s[20:23], s[0:1], 64
  s_load_dwordx2 s[24:25], s[0:1], 80
  v_lshrrev_b32 v16, 6, v0
  v_and_b32 v0, 63, v0
  s_nop 0
  v_readfirstlane_b32 s52, v16
  s_nop 3
  s_lshl_b32 s53, s52, 10
  s_and_b32 s54, s52, 1
  s_lshr_b32 s55, s52, 1
  s_and_b32 s73, s2, 7
  s_lshl_b32 s73, s73, 2
  s_bfe_u32 s76, s2, 0x20003
  s_add_u32 s73, s73, s76
  s_lshr_b32 s69, s2, 5
  s_lshl_b32 s69, s69, 8
  s_cmp_ge_u32 s73, 24
  s_cselect_b32 s71, 1, 0
  s_cbranch_scc1 L_l1_typeC
  s_lshl_b32 s74, s73, 7
  s_lshl_b32 s75, s73, 6
  s_branch L_l1_t
L_l1_typeC:
  s_sub_u32 s76, s73, 24
  s_lshl_b32 s74, s76, 6
  s_add_u32 s74, s74, 3072
  s_mul_i32 s75, s76, 192
  s_add_u32 s75, s75, 1536
L_l1_t:
  s_xor_b32 s58, s73, 0
  s_lshl_b32 s58, s58, 7
  s_add_u32 s58, s58, 64
  s_mov_b32 s70, s74
  s_mov_b32 s59, s75
  s_waitcnt lgkmcnt(0)
  s_mov_b32 s44, s24
  s_mov_b32 s45, s25
  s_mov_b32 s46, 0x10000000
  s_mov_b32 s47, 0x00020000
  s_mov_b32 s28, s4
  s_mov_b32 s29, s5
  s_mov_b32 s30, 0x400000
  s_mov_b32 s31, 0x00020000
  s_add_u32 s76, s52, 0
  s_lshr_b32 s77, s76, 2
  s_mov_b32 s32, s6
  s_mov_b32 s33, s7
  s_mov_b32 s34, 0x600000
  s_mov_b32 s64, 6144
  s_sub_u32 s78, s77, 2
  s_lshl_b32 s78, s78, 6
  s_mul_i32 s78, s78, s71
  s_add_u32 s78, s78, s75
  s_mul_i32 s79, s71, 2
  s_sub_u32 s79, 4, s79
  s_cmp_ge_u32 s77, s79
  s_cbranch_scc1 L_l1_sel0
  s_mov_b32 s34, 0x700000
  s_mov_b32 s64, 7168
  s_cmp_ge_u32 s77, 2
  s_cselect_b32 s78, s58, s74
  s_bitcmp1_b32 s77, 0
  s_cselect_b32 s32, s14, s12
  s_cselect_b32 s33, s15, s13
L_l1_sel0:
  s_mov_b32 s35, 0x00020000
  s_and_b32 s76, s76, 3
  s_lshl_b32 s76, s76, 3
  s_sub_u32 s76, s76, 32
  s_mul_i32 s76, s76, s64
  s_lshl_b32 s78, s78, 1
  s_add_u32 s60, s76, s78
  s_add_u32 s76, s52, 8
  s_lshr_b32 s77, s76, 2
  s_mov_b32 s36, s6
  s_mov_b32 s37, s7
  s_mov_b32 s38, 0x600000
  s_mov_b32 s65, 6144
  s_sub_u32 s78, s77, 2
  s_lshl_b32 s78, s78, 6
  s_mul_i32 s78, s78, s71
  s_add_u32 s78, s78, s75
  s_mul_i32 s79, s71, 2
  s_sub_u32 s79, 4, s79
  s_cmp_ge_u32 s77, s79
  s_cbranch_scc1 L_l1_sel1
  s_mov_b32 s38, 0x700000
  s_mov_b32 s65, 7168
  s_cmp_ge_u32 s77, 2
  s_cselect_b32 s78, s58, s74
  s_bitcmp1_b32 s77, 0
  s_cselect_b32 s36, s14, s12
  s_cselect_b32 s37, s15, s13
L_l1_sel1:
  s_mov_b32 s39, 0x00020000
  s_and_b32 s76, s76, 3
  s_lshl_b32 s76, s76, 3
  s_sub_u32 s76, s76, 32
  s_mul_i32 s76, s76, s65
  s_lshl_b32 s78, s78, 1
  s_add_u32 s61, s76, s78
  s_add_u32 s76, s52, 16
  s_lshr_b32 s77, s76, 2
  s_mov_b32 s40, s6
  s_mov_b32 s41, s7
  s_mov_b32 s42, 0x600000
  s_mov_b32 s66, 6144
  s_sub_u32 s78, s77, 2
  s_lshl_b32 s78, s78, 6
  s_mul_i32 s78, s78, s71
  s_add_u32 s78, s78, s75
  s_mul_i32 s79, s71, 2
  s_sub_u32 s79, 4, s79
  s_cmp_ge_u32 s77, s79
  s_cbranch_scc1 L_l1_sel2
  s_mov_b32 s42, 0x700000
  s_mov_b32 s66, 7168
  s_cmp_ge_u32 s77, 2
  s_cselect_b32 s78, s58, s74
  s_bitcmp1_b32 s77, 0
  s_cselect_b32 s40, s14, s12
  s_cselect_b32 s41, s15, s13
L_l1_sel2:
  s_mov_b32 s43, 0x00020000
  s_and_b32 s76, s76, 3
  s_lshl_b32 s76, s76, 3
  s_sub_u32 s76, s76, 32
  s_mul_i32 s76, s76, s66
  s_lshl_b32 s78, s78, 1
  s_add_u32 s62, s76, s78
  v_lshrrev_b32 v16, 3, v0
  v_bfe_u32 v17, v0, 4, 1
  s_and_b32 s77, s52, 1
  s_lshl_b32 s77, s77, 1
  v_or_b32 v17, s77, v17
  v_lshlrev_b32 v17, 1, v17
  v_xor_b32 v17, v0, v17
  v_and_b32 v17, 7, v17
  v_lshlrev_b32 v17, 4, v17
  v_mul_lo_u32 v2, v16, s64
  v_add_u32 v2, v2, v17
  v_mul_lo_u32 v22, v16, s65
  v_add_u32 v22, v22, v17
  v_mul_lo_u32 v23, v16, s66
  v_add_u32 v23, v23, v17
  s_lshl_b32 s64, s64, 5
  s_lshl_b32 s65, s65, 5
  s_lshl_b32 s66, s66, 5
  s_lshl_b32 s72, s69, 11
  v_lshrrev_b32 v16, 2, v0
  s_mov_b32 s77, 2048
  v_mul_lo_u32 v1, v16, s77
  v_lshrrev_b32 v17, 4, v0
  v_sub_u32 v17, 0, v17
  v_xor_b32 v18, v0, v17
  v_and_b32 v18, 3, v18
  v_lshl_add_u32 v1, v18, 4, v1
  s_add_u32 s78, s52, 0
  s_mul_i32 s78, s78, 32768
  s_add_u32 s56, s78, s72
  s_sub_u32 s56, s56, 0x40
  s_add_u32 s78, s52, 8
  s_mul_i32 s78, s78, 32768
  s_add_u32 s57, s78, s72
  s_sub_u32 s57, s57, 0x40
  s_mov_b32 s48, s18
  s_mov_b32 s49, s19
  s_mov_b32 s50, 0x800
  s_mov_b32 s51, 0x00020000
  v_lshlrev_b32 v40, 5, v0
  s_lshl_b32 s96, s2, 3
  s_add_u32 s96, s96, s52
  s_lshl_b32 s97, s96, 11
  buffer_load_dwordx4 v[24:27], v40, s[28:31], s97 offen
  buffer_load_dwordx4 v[28:31], v40, s[28:31], s97 offen offset:16
  buffer_load_dwordx4 v[32:35], v40, s[48:51], 0 offen
  buffer_load_dwordx4 v[36:39], v40, s[48:51], 0 offen offset:16
  s_add_u32 m0, s53, 0x0
  s_add_u32 s56, s56, 0x40
  buffer_load_dwordx4 v1, s[28:31], s56 offen lds
  s_add_u32 m0, s53, 0x2000
  s_add_u32 s57, s57, 0x40
  buffer_load_dwordx4 v1, s[28:31], s57 offen lds
  s_add_u32 m0, s53, 0x10000
  s_add_u32 s60, s60, s64
  buffer_load_dwordx4 v2, s[32:35], s60 offen lds
  s_add_u32 m0, s53, 0x12000
  s_add_u32 s61, s61, s65
  buffer_load_dwordx4 v22, s[36:39], s61 offen lds
  s_cmp_ge_u32 s52, 4
  s_cbranch_scc1 L_l1_skp0
  s_add_u32 m0, s53, 0x14000
  s_add_u32 s62, s62, s66
  buffer_load_dwordx4 v23, s[40:43], s62 offen lds
L_l1_skp0:
  v_and_b32 v16, 15, v0
  v_lshrrev_b32 v17, 4, v0
  v_lshrrev_b32 v18, 2, v16
  v_sub_u32 v19, 0, v18
  v_xor_b32 v19, v19, v17
  v_and_b32 v19, 3, v19
  s_mul_i32 s77, s55, 4096
  v_lshlrev_b32 v20, 6, v16
  v_add_u32 v20, s77, v20
  v_lshl_add_u32 v3, v19, 4, v20
  v_bfe_u32 v16, v0, 2, 2
  v_lshl_add_u32 v18, v17, 3, v16
  v_lshlrev_b32 v18, 7, v18
  v_and_b32 v19, 3, v0
  v_lshl_add_u32 v18, v19, 3, v18
  v_add_u32 v18, 0x10000, v18
  v_bfe_u32 v19, v0, 3, 1
  v_bfe_u32 v20, v0, 4, 1
  v_lshl_or_b32 v19, v20, 1, v19
  s_mul_i32 s77, s54, 8192
  v_xor_b32 v20, 0, v19
  v_lshl_add_u32 v20, v20, 5, v18
  v_add_u32 v4, s77, v20
  v_xor_b32 v20, 1, v19
  v_lshl_add_u32 v20, v20, 5, v18
  v_add_u32 v5, s77, v20
  v_xor_b32 v20, 2, v19
  v_lshl_add_u32 v20, v20, 5, v18
  v_add_u32 v6, s77, v20
  v_xor_b32 v20, 3, v19
  v_lshl_add_u32 v20, v20, 5, v18
  v_add_u32 v7, s77, v20
  s_lshl_b32 s77, s54, 1
  s_add_u32 s77, s77, 0
  v_xor_b32 v20, s77, v19
  v_lshl_add_u32 v20, v20, 5, v18
  v_add_u32 v8, 0x4000, v20
  s_lshl_b32 s77, s54, 1
  s_add_u32 s77, s77, 1
  v_xor_b32 v20, s77, v19
  v_lshl_add_u32 v20, v20, 5, v18
  v_add_u32 v9, 0x4000, v20
  v_add_u32 v10, 0xf000, v4
  v_add_u32 v11, 0xf000, v5
  v_add_u32 v12, 0xf000, v6
  v_add_u32 v13, 0xf000, v7
  v_add_u32 v14, 0xf000, v8
  v_add_u32 v15, 0xf000, v9
  v_mov_b32 v96, 0
  v_mov_b32 v97, 0
  v_mov_b32 v98, 0
  v_mov_b32 v99, 0
  v_mov_b32 v100, 0
  v_mov_b32 v101, 0
  v_mov_b32 v102, 0
  v_mov_b32 v103, 0
  v_mov_b32 v104, 0
  v_mov_b32 v105, 0
  v_mov_b32 v106, 0
  v_mov_b32 v107, 0
  v_mov_b32 v108, 0
  v_mov_b32 v109, 0
  v_mov_b32 v110, 0
  v_mov_b32 v111, 0
  v_mov_b32 v112, 0
  v_mov_b32 v113, 0
  v_mov_b32 v114, 0
  v_mov_b32 v115, 0
  v_mov_b32 v116, 0
  v_mov_b32 v117, 0
  v_mov_b32 v118, 0
  v_mov_b32 v119, 0
  v_mov_b32 v120, 0
  v_mov_b32 v121, 0
  v_mov_b32 v122, 0
  v_mov_b32 v123, 0
  v_mov_b32 v124, 0
  v_mov_b32 v125, 0
  v_mov_b32 v126, 0
  v_mov_b32 v127, 0
  v_mov_b32 v128, 0
  v_mov_b32 v129, 0
  v_mov_b32 v130, 0
  v_mov_b32 v131, 0
  v_mov_b32 v132, 0
  v_mov_b32 v133, 0
  v_mov_b32 v134, 0
  v_mov_b32 v135, 0
  v_mov_b32 v136, 0
  v_mov_b32 v137, 0
  v_mov_b32 v138, 0
  v_mov_b32 v139, 0
  v_mov_b32 v140, 0
  v_mov_b32 v141, 0
  v_mov_b32 v142, 0
  v_mov_b32 v143, 0
  v_mov_b32 v144, 0
  v_mov_b32 v145, 0
  v_mov_b32 v146, 0
  v_mov_b32 v147, 0
  v_mov_b32 v148, 0
  v_mov_b32 v149, 0
  v_mov_b32 v150, 0
  v_mov_b32 v151, 0
  v_mov_b32 v152, 0
  v_mov_b32 v153, 0
  v_mov_b32 v154, 0
  v_mov_b32 v155, 0
  v_mov_b32 v156, 0
  v_mov_b32 v157, 0
  v_mov_b32 v158, 0
  v_mov_b32 v159, 0
  v_mov_b32 v160, 0
  v_mov_b32 v161, 0
  v_mov_b32 v162, 0
  v_mov_b32 v163, 0
  v_mov_b32 v164, 0
  v_mov_b32 v165, 0
  v_mov_b32 v166, 0
  v_mov_b32 v167, 0
  v_mov_b32 v168, 0
  v_mov_b32 v169, 0
  v_mov_b32 v170, 0
  v_mov_b32 v171, 0
  v_mov_b32 v172, 0
  v_mov_b32 v173, 0
  v_mov_b32 v174, 0
  v_mov_b32 v175, 0
  v_mov_b32 v176, 0
  v_mov_b32 v177, 0
  v_mov_b32 v178, 0
  v_mov_b32 v179, 0
  v_mov_b32 v180, 0
  v_mov_b32 v181, 0
  v_mov_b32 v182, 0
  v_mov_b32 v183, 0
  v_mov_b32 v184, 0
  v_mov_b32 v185, 0
  v_mov_b32 v186, 0
  v_mov_b32 v187, 0
  v_mov_b32 v188, 0
  v_mov_b32 v189, 0
  v_mov_b32 v190, 0
  v_mov_b32 v191, 0
  v_mov_b32 v192, 0
  v_mov_b32 v193, 0
  v_mov_b32 v194, 0
  v_mov_b32 v195, 0
  v_mov_b32 v196, 0
  v_mov_b32 v197, 0
  v_mov_b32 v198, 0
  v_mov_b32 v199, 0
  v_mov_b32 v200, 0
  v_mov_b32 v201, 0
  v_mov_b32 v202, 0
  v_mov_b32 v203, 0
  v_mov_b32 v204, 0
  v_mov_b32 v205, 0
  v_mov_b32 v206, 0
  v_mov_b32 v207, 0
  v_mov_b32 v208, 0
  v_mov_b32 v209, 0
  v_mov_b32 v210, 0
  v_mov_b32 v211, 0
  v_mov_b32 v212, 0
  v_mov_b32 v213, 0
  v_mov_b32 v214, 0
  v_mov_b32 v215, 0
  v_mov_b32 v216, 0
  v_mov_b32 v217, 0
  v_mov_b32 v218, 0
  v_mov_b32 v219, 0
  v_mov_b32 v220, 0
  v_mov_b32 v221, 0
  v_mov_b32 v222, 0
  v_mov_b32 v223, 0
  v_mov_b32 v224, 0
  v_mov_b32 v225, 0
  v_mov_b32 v226, 0
  v_mov_b32 v227, 0
  v_mov_b32 v228, 0
  v_mov_b32 v229, 0
  v_mov_b32 v230, 0
  v_mov_b32 v231, 0
  v_mov_b32 v232, 0
  v_mov_b32 v233, 0
  v_mov_b32 v234, 0
  v_mov_b32 v235, 0
  v_mov_b32 v236, 0
  v_mov_b32 v237, 0
  v_mov_b32 v238, 0
  v_mov_b32 v239, 0
  v_mov_b32 v240, 0
  v_mov_b32 v241, 0
  v_mov_b32 v242, 0
  v_mov_b32 v243, 0
  v_mov_b32 v244, 0
  v_mov_b32 v245, 0
  v_mov_b32 v246, 0
  v_mov_b32 v247, 0
  v_mov_b32 v248, 0
  v_mov_b32 v249, 0
  v_mov_b32 v250, 0
  v_mov_b32 v251, 0
  v_mov_b32 v252, 0
  v_mov_b32 v253, 0
  v_mov_b32 v254, 0
  v_mov_b32 v255, 0
  s_waitcnt vmcnt(4)
  v_lshlrev_b32 v42, 16, v24
  v_lshlrev_b32 v43, 16, v32
  v_and_b32 v44, 0xffff0000, v24
  v_and_b32 v45, 0xffff0000, v32
  v_mul_f32 v41, v42, v43
  v_fmac_f32 v41, v44, v45
  v_lshlrev_b32 v42, 16, v25
  v_lshlrev_b32 v43, 16, v33
  v_and_b32 v44, 0xffff0000, v25
  v_and_b32 v45, 0xffff0000, v33
  v_fmac_f32 v41, v42, v43
  v_fmac_f32 v41, v44, v45
  v_lshlrev_b32 v42, 16, v26
  v_lshlrev_b32 v43, 16, v34
  v_and_b32 v44, 0xffff0000, v26
  v_and_b32 v45, 0xffff0000, v34
  v_fmac_f32 v41, v42, v43
  v_fmac_f32 v41, v44, v45
  v_lshlrev_b32 v42, 16, v27
  v_lshlrev_b32 v43, 16, v35
  v_and_b32 v44, 0xffff0000, v27
  v_and_b32 v45, 0xffff0000, v35
  v_fmac_f32 v41, v42, v43
  v_fmac_f32 v41, v44, v45
  v_lshlrev_b32 v42, 16, v28
  v_lshlrev_b32 v43, 16, v36
  v_and_b32 v44, 0xffff0000, v28
  v_and_b32 v45, 0xffff0000, v36
  v_fmac_f32 v41, v42, v43
  v_fmac_f32 v41, v44, v45
  v_lshlrev_b32 v42, 16, v29
  v_lshlrev_b32 v43, 16, v37
  v_and_b32 v44, 0xffff0000, v29
  v_and_b32 v45, 0xffff0000, v37
  v_fmac_f32 v41, v42, v43
  v_fmac_f32 v41, v44, v45
  v_lshlrev_b32 v42, 16, v30
  v_lshlrev_b32 v43, 16, v38
  v_and_b32 v44, 0xffff0000, v30
  v_and_b32 v45, 0xffff0000, v38
  v_fmac_f32 v41, v42, v43
  v_fmac_f32 v41, v44, v45
  v_lshlrev_b32 v42, 16, v31
  v_lshlrev_b32 v43, 16, v39
  v_and_b32 v44, 0xffff0000, v31
  v_and_b32 v45, 0xffff0000, v39
  v_fmac_f32 v41, v42, v43
  v_fmac_f32 v41, v44, v45
  ds_swizzle_b32 v42, v41 offset:0x41f
  s_waitcnt lgkmcnt(0)
  v_add_f32 v41, v41, v42
  ds_swizzle_b32 v42, v41 offset:0x81f
  s_waitcnt lgkmcnt(0)
  v_add_f32 v41, v41, v42
  ds_swizzle_b32 v42, v41 offset:0x101f
  s_waitcnt lgkmcnt(0)
  v_add_f32 v41, v41, v42
  ds_swizzle_b32 v42, v41 offset:0x201f
  s_waitcnt lgkmcnt(0)
  v_add_f32 v41, v41, v42
  ds_swizzle_b32 v42, v41 offset:0x401f
  s_waitcnt lgkmcnt(0)
  v_add_f32 v41, v41, v42
  v_mov_b32 v42, v41
  s_nop 1
  v_permlane32_swap_b32 v41, v42
  s_nop 1
  v_add_f32 v41, v41, v42
  v_mul_f32 v41, 0xbfb8aa3b, v41
  v_exp_f32 v41, v41
  s_nop 0
  v_add_f32 v41, 1.0, v41
  v_rcp_f32 v41, v41
  v_mov_b32 v42, 0
  s_lshl_b32 s96, s96, 2
  s_add_u32 s96, s96, 0x3000000
  v_cmp_eq_u32 vcc, 0, v0
  s_and_saveexec_b64 s[98:99], vcc
  buffer_store_dword v41, v42, s[44:47], s96 offen
  s_mov_b64 exec, s[98:99]
  s_add_u32 m0, s53, 0x4000
  s_add_u32 s56, s56, 0x40
  buffer_load_dwordx4 v1, s[28:31], s56 offen lds
  s_add_u32 m0, s53, 0x6000
  s_add_u32 s57, s57, 0x40
  buffer_load_dwordx4 v1, s[28:31], s57 offen lds
  s_add_u32 m0, s53, 0x15000
  s_add_u32 s60, s60, s64
  buffer_load_dwordx4 v2, s[32:35], s60 offen lds
  s_add_u32 m0, s53, 0x17000
  s_add_u32 s61, s61, s65
  buffer_load_dwordx4 v22, s[36:39], s61 offen lds
  s_cmp_ge_u32 s52, 4
  s_cbranch_scc1 L_l1_skp1
  s_add_u32 m0, s53, 0x19000
  s_add_u32 s62, s62, s66
  buffer_load_dwordx4 v23, s[40:43], s62 offen lds
L_l1_skp1:
  s_add_u32 m0, s53, 0x8000
  s_add_u32 s56, s56, 0x40
  buffer_load_dwordx4 v1, s[28:31], s56 offen lds
  s_add_u32 m0, s53, 0xa000
  s_add_u32 s57, s57, 0x40
  buffer_load_dwordx4 v1, s[28:31], s57 offen lds
  s_add_u32 m0, s53, 0x1a000
  s_add_u32 s60, s60, s64
  buffer_load_dwordx4 v2, s[32:35], s60 offen lds
  s_add_u32 m0, s53, 0x1c000
  s_add_u32 s61, s61, s65
  buffer_load_dwordx4 v22, s[36:39], s61 offen lds
  s_cmp_ge_u32 s52, 4
  s_cbranch_scc1 L_l1_skp2
  s_add_u32 m0, s53, 0x1e000
  s_add_u32 s62, s62, s66
  buffer_load_dwordx4 v23, s[40:43], s62 offen lds
L_l1_skp2:
  s_add_u32 m0, s53, 0xc000
  s_add_u32 s56, s56, 0x40
  buffer_load_dwordx4 v1, s[28:31], s56 offen lds
  s_add_u32 m0, s53, 0xe000
  s_add_u32 s57, s57, 0x40
  buffer_load_dwordx4 v1, s[28:31], s57 offen lds
  s_add_u32 m0, s53, 0x1f000
  s_add_u32 s60, s60, s64
  buffer_load_dwordx4 v2, s[32:35], s60 offen lds
  s_add_u32 m0, s53, 0x21000
  s_add_u32 s61, s61, s65
  buffer_load_dwordx4 v22, s[36:39], s61 offen lds
  s_cmp_ge_u32 s52, 4
  s_cbranch_scc1 L_l1_skp3
  s_add_u32 m0, s53, 0x23000
  s_add_u32 s62, s62, s66
  buffer_load_dwordx4 v23, s[40:43], s62 offen lds
L_l1_skp3:
  s_waitcnt vmcnt(12)
  s_barrier
  ds_read_b128 v[64:67], v3 offset:0
  ds_read_b128 v[68:71], v3 offset:1024
  ds_read_b128 v[72:75], v3 offset:2048
  ds_read_b128 v[76:79], v3 offset:3072
  ds_read_b64_tr_b16 v[24:25], v4 offset:0
  ds_read_b64_tr_b16 v[26:27], v4 offset:512
  ds_read_b64_tr_b16 v[28:29], v5 offset:0
  ds_read_b64_tr_b16 v[30:31], v5 offset:512
  ds_read_b64_tr_b16 v[32:33], v6 offset:0
  ds_read_b64_tr_b16 v[34:35], v6 offset:512
  ds_read_b64_tr_b16 v[36:37], v7 offset:0
  ds_read_b64_tr_b16 v[38:39], v7 offset:512
  ds_read_b64_tr_b16 v[40:41], v4 offset:4096
  ds_read_b64_tr_b16 v[42:43], v4 offset:4608
  s_mov_b32 s68, 7
L_l1_loop:
  s_waitcnt lgkmcnt(0)
  v_mfma_f32_16x16x32_bf16 v[96:99], v[24:27], v[64:67], v[96:99]
  ds_read_b64_tr_b16 v[44:45], v5 offset:4096
  v_mfma_f32_16x16x32_bf16 v[100:103], v[24:27], v[68:71], v[100:103]
  v_mfma_f32_16x16x32_bf16 v[104:107], v[24:27], v[72:75], v[104:107]
  ds_read_b64_tr_b16 v[46:47], v5 offset:4608
  v_mfma_f32_16x16x32_bf16 v[108:111], v[24:27], v[76:79], v[108:111]
  v_mfma_f32_16x16x32_bf16 v[112:115], v[28:31], v[64:67], v[112:115]
  ds_read_b64_tr_b16 v[48:49], v6 offset:4096
  v_mfma_f32_16x16x32_bf16 v[116:119], v[28:31], v[68:71], v[116:119]
  v_mfma_f32_16x16x32_bf16 v[120:123], v[28:31], v[72:75], v[120:123]
  ds_read_b64_tr_b16 v[50:51], v6 offset:4608
  v_mfma_f32_16x16x32_bf16 v[124:127], v[28:31], v[76:79], v[124:127]
  v_mfma_f32_16x16x32_bf16 v[128:131], v[32:35], v[64:67], v[128:131]
  ds_read_b64_tr_b16 v[52:53], v7 offset:4096
  v_mfma_f32_16x16x32_bf16 v[132:135], v[32:35], v[68:71], v[132:135]
  v_mfma_f32_16x16x32_bf16 v[136:139], v[32:35], v[72:75], v[136:139]
  ds_read_b64_tr_b16 v[54:55], v7 offset:4608
  v_mfma_f32_16x16x32_bf16 v[140:143], v[32:35], v[76:79], v[140:143]
  v_mfma_f32_16x16x32_bf16 v[144:147], v[36:39], v[64:67], v[144:147]
  ds_read_b64_tr_b16 v[56:57], v8 offset:0
  v_mfma_f32_16x16x32_bf16 v[148:151], v[36:39], v[68:71], v[148:151]
  v_mfma_f32_16x16x32_bf16 v[152:155], v[36:39], v[72:75], v[152:155]
  ds_read_b64_tr_b16 v[58:59], v8 offset:512
  v_mfma_f32_16x16x32_bf16 v[156:159], v[36:39], v[76:79], v[156:159]
  v_mfma_f32_16x16x32_bf16 v[160:163], v[40:43], v[64:67], v[160:163]
  ds_read_b64_tr_b16 v[60:61], v9 offset:0
  v_mfma_f32_16x16x32_bf16 v[164:167], v[40:43], v[68:71], v[164:167]
  v_mfma_f32_16x16x32_bf16 v[168:171], v[40:43], v[72:75], v[168:171]
  ds_read_b64_tr_b16 v[62:63], v9 offset:512
  v_mfma_f32_16x16x32_bf16 v[172:175], v[40:43], v[76:79], v[172:175]
  s_waitcnt vmcnt(8) lgkmcnt(0)
  s_barrier
  v_mfma_f32_16x16x32_bf16 v[176:179], v[44:47], v[64:67], v[176:179]
  ds_read_b128 v[80:83], v3 offset:16384
  ds_read_b64_tr_b16 v[24:25], v4 offset:20480
  v_mfma_f32_16x16x32_bf16 v[180:183], v[44:47], v[68:71], v[180:183]
  ds_read_b64_tr_b16 v[26:27], v4 offset:20992
  v_mfma_f32_16x16x32_bf16 v[184:187], v[44:47], v[72:75], v[184:187]
  ds_read_b128 v[84:87], v3 offset:17408
  ds_read_b128 v[88:91], v3 offset:18432
  v_mfma_f32_16x16x32_bf16 v[188:191], v[44:47], v[76:79], v[188:191]
  ds_read_b128 v[92:95], v3 offset:19456
  v_mfma_f32_16x16x32_bf16 v[192:195], v[48:51], v[64:67], v[192:195]
  ds_read_b64_tr_b16 v[28:29], v5 offset:20480
  v_mfma_f32_16x16x32_bf16 v[196:199], v[48:51], v[68:71], v[196:199]
  ds_read_b64_tr_b16 v[30:31], v5 offset:20992
  ds_read_b64_tr_b16 v[32:33], v6 offset:20480
  v_mfma_f32_16x16x32_bf16 v[200:203], v[48:51], v[72:75], v[200:203]
  ds_read_b64_tr_b16 v[34:35], v6 offset:20992
  v_mfma_f32_16x16x32_bf16 v[204:207], v[48:51], v[76:79], v[204:207]
  ds_read_b64_tr_b16 v[36:37], v7 offset:20480
  v_mfma_f32_16x16x32_bf16 v[208:211], v[52:55], v[64:67], v[208:211]
  ds_read_b64_tr_b16 v[38:39], v7 offset:20992
  ds_read_b64_tr_b16 v[40:41], v4 offset:24576
  v_mfma_f32_16x16x32_bf16 v[212:215], v[52:55], v[68:71], v[212:215]
  ds_read_b64_tr_b16 v[42:43], v4 offset:25088
  v_mfma_f32_16x16x32_bf16 v[216:219], v[52:55], v[72:75], v[216:219]
  s_add_u32 m0, s53, 0x0
  v_mfma_f32_16x16x32_bf16 v[220:223], v[52:55], v[76:79], v[220:223]
  s_add_u32 s56, s56, 0x40
  buffer_load_dwordx4 v1, s[28:31], s56 offen lds
  v_mfma_f32_16x16x32_bf16 v[224:227], v[56:59], v[64:67], v[224:227]
  s_add_u32 m0, s53, 0x2000
  v_mfma_f32_16x16x32_bf16 v[228:231], v[56:59], v[68:71], v[228:231]
  s_add_u32 s57, s57, 0x40
  v_mfma_f32_16x16x32_bf16 v[232:235], v[56:59], v[72:75], v[232:235]
  buffer_load_dwordx4 v1, s[28:31], s57 offen lds
  s_add_u32 m0, s53, 0x10000
  v_mfma_f32_16x16x32_bf16 v[236:239], v[56:59], v[76:79], v[236:239]
  s_add_u32 s60, s60, s64
  v_mfma_f32_16x16x32_bf16 v[240:243], v[60:63], v[64:67], v[240:243]
  buffer_load_dwordx4 v2, s[32:35], s60 offen lds
  v_mfma_f32_16x16x32_bf16 v[244:247], v[60:63], v[68:71], v[244:247]
  s_add_u32 m0, s53, 0x12000
  s_add_u32 s61, s61, s65
  v_mfma_f32_16x16x32_bf16 v[248:251], v[60:63], v[72:75], v[248:251]
  buffer_load_dwordx4 v22, s[36:39], s61 offen lds
  v_mfma_f32_16x16x32_bf16 v[252:255], v[60:63], v[76:79], v[252:255]
  s_cmp_ge_u32 s52, 4
  s_cbranch_scc1 L_l1_skl0
  s_add_u32 m0, s53, 0x14000
  s_add_u32 s62, s62, s66
  buffer_load_dwordx4 v23, s[40:43], s62 offen lds
L_l1_skl0:
  s_waitcnt lgkmcnt(0)
  v_mfma_f32_16x16x32_bf16 v[96:99], v[24:27], v[80:83], v[96:99]
  ds_read_b64_tr_b16 v[44:45], v5 offset:24576
  v_mfma_f32_16x16x32_bf16 v[100:103], v[24:27], v[84:87], v[100:103]
  v_mfma_f32_16x16x32_bf16 v[104:107], v[24:27], v[88:91], v[104:107]
  ds_read_b64_tr_b16 v[46:47], v5 offset:25088
  v_mfma_f32_16x16x32_bf16 v[108:111], v[24:27], v[92:95], v[108:111]
  v_mfma_f32_16x16x32_bf16 v[112:115], v[28:31], v[80:83], v[112:115]
  ds_read_b64_tr_b16 v[48:49], v6 offset:24576
  v_mfma_f32_16x16x32_bf16 v[116:119], v[28:31], v[84:87], v[116:119]
  v_mfma_f32_16x16x32_bf16 v[120:123], v[28:31], v[88:91], v[120:123]
  ds_read_b64_tr_b16 v[50:51], v6 offset:25088
  v_mfma_f32_16x16x32_bf16 v[124:127], v[28:31], v[92:95], v[124:127]
  v_mfma_f32_16x16x32_bf16 v[128:131], v[32:35], v[80:83], v[128:131]
  ds_read_b64_tr_b16 v[52:53], v7 offset:24576
  v_mfma_f32_16x16x32_bf16 v[132:135], v[32:35], v[84:87], v[132:135]
  v_mfma_f32_16x16x32_bf16 v[136:139], v[32:35], v[88:91], v[136:139]
  ds_read_b64_tr_b16 v[54:55], v7 offset:25088
  v_mfma_f32_16x16x32_bf16 v[140:143], v[32:35], v[92:95], v[140:143]
  v_mfma_f32_16x16x32_bf16 v[144:147], v[36:39], v[80:83], v[144:147]
  ds_read_b64_tr_b16 v[56:57], v8 offset:20480
  v_mfma_f32_16x16x32_bf16 v[148:151], v[36:39], v[84:87], v[148:151]
  v_mfma_f32_16x16x32_bf16 v[152:155], v[36:39], v[88:91], v[152:155]
  ds_read_b64_tr_b16 v[58:59], v8 offset:20992
  v_mfma_f32_16x16x32_bf16 v[156:159], v[36:39], v[92:95], v[156:159]
  v_mfma_f32_16x16x32_bf16 v[160:163], v[40:43], v[80:83], v[160:163]
  ds_read_b64_tr_b16 v[60:61], v9 offset:20480
  v_mfma_f32_16x16x32_bf16 v[164:167], v[40:43], v[84:87], v[164:167]
  v_mfma_f32_16x16x32_bf16 v[168:171], v[40:43], v[88:91], v[168:171]
  ds_read_b64_tr_b16 v[62:63], v9 offset:20992
  v_mfma_f32_16x16x32_bf16 v[172:175], v[40:43], v[92:95], v[172:175]
  s_waitcnt vmcnt(8) lgkmcnt(0)
  s_barrier
  v_mfma_f32_16x16x32_bf16 v[176:179], v[44:47], v[80:83], v[176:179]
  ds_read_b128 v[64:67], v3 offset:32768
  ds_read_b64_tr_b16 v[24:25], v4 offset:40960
  v_mfma_f32_16x16x32_bf16 v[180:183], v[44:47], v[84:87], v[180:183]
  ds_read_b64_tr_b16 v[26:27], v4 offset:41472
  v_mfma_f32_16x16x32_bf16 v[184:187], v[44:47], v[88:91], v[184:187]
  ds_read_b128 v[68:71], v3 offset:33792
  ds_read_b128 v[72:75], v3 offset:34816
  v_mfma_f32_16x16x32_bf16 v[188:191], v[44:47], v[92:95], v[188:191]
  ds_read_b128 v[76:79], v3 offset:35840
  v_mfma_f32_16x16x32_bf16 v[192:195], v[48:51], v[80:83], v[192:195]
  ds_read_b64_tr_b16 v[28:29], v5 offset:40960
  v_mfma_f32_16x16x32_bf16 v[196:199], v[48:51], v[84:87], v[196:199]
  ds_read_b64_tr_b16 v[30:31], v5 offset:41472
  ds_read_b64_tr_b16 v[32:33], v6 offset:40960
  v_mfma_f32_16x16x32_bf16 v[200:203], v[48:51], v[88:91], v[200:203]
  ds_read_b64_tr_b16 v[34:35], v6 offset:41472
  v_mfma_f32_16x16x32_bf16 v[204:207], v[48:51], v[92:95], v[204:207]
  ds_read_b64_tr_b16 v[36:37], v7 offset:40960
  v_mfma_f32_16x16x32_bf16 v[208:211], v[52:55], v[80:83], v[208:211]
  ds_read_b64_tr_b16 v[38:39], v7 offset:41472
  ds_read_b64_tr_b16 v[40:41], v4 offset:45056
  v_mfma_f32_16x16x32_bf16 v[212:215], v[52:55], v[84:87], v[212:215]
  ds_read_b64_tr_b16 v[42:43], v4 offset:45568
  v_mfma_f32_16x16x32_bf16 v[216:219], v[52:55], v[88:91], v[216:219]
  s_add_u32 m0, s53, 0x4000
  v_mfma_f32_16x16x32_bf16 v[220:223], v[52:55], v[92:95], v[220:223]
  s_add_u32 s56, s56, 0x40
  buffer_load_dwordx4 v1, s[28:31], s56 offen lds
  v_mfma_f32_16x16x32_bf16 v[224:227], v[56:59], v[80:83], v[224:227]
  s_add_u32 m0, s53, 0x6000
  v_mfma_f32_16x16x32_bf16 v[228:231], v[56:59], v[84:87], v[228:231]
  s_add_u32 s57, s57, 0x40
  v_mfma_f32_16x16x32_bf16 v[232:235], v[56:59], v[88:91], v[232:235]
  buffer_load_dwordx4 v1, s[28:31], s57 offen lds
  s_add_u32 m0, s53, 0x15000
  v_mfma_f32_16x16x32_bf16 v[236:239], v[56:59], v[92:95], v[236:239]
  s_add_u32 s60, s60, s64
  v_mfma_f32_16x16x32_bf16 v[240:243], v[60:63], v[80:83], v[240:243]
  buffer_load_dwordx4 v2, s[32:35], s60 offen lds
  v_mfma_f32_16x16x32_bf16 v[244:247], v[60:63], v[84:87], v[244:247]
  s_add_u32 m0, s53, 0x17000
  s_add_u32 s61, s61, s65
  v_mfma_f32_16x16x32_bf16 v[248:251], v[60:63], v[88:91], v[248:251]
  buffer_load_dwordx4 v22, s[36:39], s61 offen lds
  v_mfma_f32_16x16x32_bf16 v[252:255], v[60:63], v[92:95], v[252:255]
  s_cmp_ge_u32 s52, 4
  s_cbranch_scc1 L_l1_skl1
  s_add_u32 m0, s53, 0x19000
  s_add_u32 s62, s62, s66
  buffer_load_dwordx4 v23, s[40:43], s62 offen lds
L_l1_skl1:
  s_waitcnt lgkmcnt(0)
  v_mfma_f32_16x16x32_bf16 v[96:99], v[24:27], v[64:67], v[96:99]
  ds_read_b64_tr_b16 v[44:45], v5 offset:45056
  v_mfma_f32_16x16x32_bf16 v[100:103], v[24:27], v[68:71], v[100:103]
  v_mfma_f32_16x16x32_bf16 v[104:107], v[24:27], v[72:75], v[104:107]
  ds_read_b64_tr_b16 v[46:47], v5 offset:45568
  v_mfma_f32_16x16x32_bf16 v[108:111], v[24:27], v[76:79], v[108:111]
  v_mfma_f32_16x16x32_bf16 v[112:115], v[28:31], v[64:67], v[112:115]
  ds_read_b64_tr_b16 v[48:49], v6 offset:45056
  v_mfma_f32_16x16x32_bf16 v[116:119], v[28:31], v[68:71], v[116:119]
  v_mfma_f32_16x16x32_bf16 v[120:123], v[28:31], v[72:75], v[120:123]
  ds_read_b64_tr_b16 v[50:51], v6 offset:45568
  v_mfma_f32_16x16x32_bf16 v[124:127], v[28:31], v[76:79], v[124:127]
  v_mfma_f32_16x16x32_bf16 v[128:131], v[32:35], v[64:67], v[128:131]
  ds_read_b64_tr_b16 v[52:53], v7 offset:45056
  v_mfma_f32_16x16x32_bf16 v[132:135], v[32:35], v[68:71], v[132:135]
  v_mfma_f32_16x16x32_bf16 v[136:139], v[32:35], v[72:75], v[136:139]
  ds_read_b64_tr_b16 v[54:55], v7 offset:45568
  v_mfma_f32_16x16x32_bf16 v[140:143], v[32:35], v[76:79], v[140:143]
  v_mfma_f32_16x16x32_bf16 v[144:147], v[36:39], v[64:67], v[144:147]
  ds_read_b64_tr_b16 v[56:57], v8 offset:40960
  v_mfma_f32_16x16x32_bf16 v[148:151], v[36:39], v[68:71], v[148:151]
  v_mfma_f32_16x16x32_bf16 v[152:155], v[36:39], v[72:75], v[152:155]
  ds_read_b64_tr_b16 v[58:59], v8 offset:41472
  v_mfma_f32_16x16x32_bf16 v[156:159], v[36:39], v[76:79], v[156:159]
  v_mfma_f32_16x16x32_bf16 v[160:163], v[40:43], v[64:67], v[160:163]
  ds_read_b64_tr_b16 v[60:61], v9 offset:40960
  v_mfma_f32_16x16x32_bf16 v[164:167], v[40:43], v[68:71], v[164:167]
  v_mfma_f32_16x16x32_bf16 v[168:171], v[40:43], v[72:75], v[168:171]
  ds_read_b64_tr_b16 v[62:63], v9 offset:41472
  v_mfma_f32_16x16x32_bf16 v[172:175], v[40:43], v[76:79], v[172:175]
  s_waitcnt vmcnt(8) lgkmcnt(0)
  s_barrier
  v_mfma_f32_16x16x32_bf16 v[176:179], v[44:47], v[64:67], v[176:179]
  ds_read_b128 v[80:83], v3 offset:49152
  ds_read_b64_tr_b16 v[24:25], v10 offset:0
  v_mfma_f32_16x16x32_bf16 v[180:183], v[44:47], v[68:71], v[180:183]
  ds_read_b64_tr_b16 v[26:27], v10 offset:512
  v_mfma_f32_16x16x32_bf16 v[184:187], v[44:47], v[72:75], v[184:187]
  ds_read_b128 v[84:87], v3 offset:50176
  ds_read_b128 v[88:91], v3 offset:51200
  v_mfma_f32_16x16x32_bf16 v[188:191], v[44:47], v[76:79], v[188:191]
  ds_read_b128 v[92:95], v3 offset:52224
  v_mfma_f32_16x16x32_bf16 v[192:195], v[48:51], v[64:67], v[192:195]
  ds_read_b64_tr_b16 v[28:29], v11 offset:0
  v_mfma_f32_16x16x32_bf16 v[196:199], v[48:51], v[68:71], v[196:199]
  ds_read_b64_tr_b16 v[30:31], v11 offset:512
  ds_read_b64_tr_b16 v[32:33], v12 offset:0
  v_mfma_f32_16x16x32_bf16 v[200:203], v[48:51], v[72:75], v[200:203]
  ds_read_b64_tr_b16 v[34:35], v12 offset:512
  v_mfma_f32_16x16x32_bf16 v[204:207], v[48:51], v[76:79], v[204:207]
  ds_read_b64_tr_b16 v[36:37], v13 offset:0
  v_mfma_f32_16x16x32_bf16 v[208:211], v[52:55], v[64:67], v[208:211]
  ds_read_b64_tr_b16 v[38:39], v13 offset:512
  ds_read_b64_tr_b16 v[40:41], v10 offset:4096
  v_mfma_f32_16x16x32_bf16 v[212:215], v[52:55], v[68:71], v[212:215]
  ds_read_b64_tr_b16 v[42:43], v10 offset:4608
  v_mfma_f32_16x16x32_bf16 v[216:219], v[52:55], v[72:75], v[216:219]
  s_add_u32 m0, s53, 0x8000
  v_mfma_f32_16x16x32_bf16 v[220:223], v[52:55], v[76:79], v[220:223]
  s_add_u32 s56, s56, 0x40
  buffer_load_dwordx4 v1, s[28:31], s56 offen lds
  v_mfma_f32_16x16x32_bf16 v[224:227], v[56:59], v[64:67], v[224:227]
  s_add_u32 m0, s53, 0xa000
  v_mfma_f32_16x16x32_bf16 v[228:231], v[56:59], v[68:71], v[228:231]
  s_add_u32 s57, s57, 0x40
  v_mfma_f32_16x16x32_bf16 v[232:235], v[56:59], v[72:75], v[232:235]
  buffer_load_dwordx4 v1, s[28:31], s57 offen lds
  s_add_u32 m0, s53, 0x1a000
  v_mfma_f32_16x16x32_bf16 v[236:239], v[56:59], v[76:79], v[236:239]
  s_add_u32 s60, s60, s64
  v_mfma_f32_16x16x32_bf16 v[240:243], v[60:63], v[64:67], v[240:243]
  buffer_load_dwordx4 v2, s[32:35], s60 offen lds
  v_mfma_f32_16x16x32_bf16 v[244:247], v[60:63], v[68:71], v[244:247]
  s_add_u32 m0, s53, 0x1c000
  s_add_u32 s61, s61, s65
  v_mfma_f32_16x16x32_bf16 v[248:251], v[60:63], v[72:75], v[248:251]
  buffer_load_dwordx4 v22, s[36:39], s61 offen lds
  v_mfma_f32_16x16x32_bf16 v[252:255], v[60:63], v[76:79], v[252:255]
  s_cmp_ge_u32 s52, 4
  s_cbranch_scc1 L_l1_skl2
  s_add_u32 m0, s53, 0x1e000
  s_add_u32 s62, s62, s66
  buffer_load_dwordx4 v23, s[40:43], s62 offen lds
L_l1_skl2:
  s_waitcnt lgkmcnt(0)
  v_mfma_f32_16x16x32_bf16 v[96:99], v[24:27], v[80:83], v[96:99]
  ds_read_b64_tr_b16 v[44:45], v11 offset:4096
  v_mfma_f32_16x16x32_bf16 v[100:103], v[24:27], v[84:87], v[100:103]
  v_mfma_f32_16x16x32_bf16 v[104:107], v[24:27], v[88:91], v[104:107]
  ds_read_b64_tr_b16 v[46:47], v11 offset:4608
  v_mfma_f32_16x16x32_bf16 v[108:111], v[24:27], v[92:95], v[108:111]
  v_mfma_f32_16x16x32_bf16 v[112:115], v[28:31], v[80:83], v[112:115]
  ds_read_b64_tr_b16 v[48:49], v12 offset:4096
  v_mfma_f32_16x16x32_bf16 v[116:119], v[28:31], v[84:87], v[116:119]
  v_mfma_f32_16x16x32_bf16 v[120:123], v[28:31], v[88:91], v[120:123]
  ds_read_b64_tr_b16 v[50:51], v12 offset:4608
  v_mfma_f32_16x16x32_bf16 v[124:127], v[28:31], v[92:95], v[124:127]
  v_mfma_f32_16x16x32_bf16 v[128:131], v[32:35], v[80:83], v[128:131]
  ds_read_b64_tr_b16 v[52:53], v13 offset:4096
  v_mfma_f32_16x16x32_bf16 v[132:135], v[32:35], v[84:87], v[132:135]
  v_mfma_f32_16x16x32_bf16 v[136:139], v[32:35], v[88:91], v[136:139]
  ds_read_b64_tr_b16 v[54:55], v13 offset:4608
  v_mfma_f32_16x16x32_bf16 v[140:143], v[32:35], v[92:95], v[140:143]
  v_mfma_f32_16x16x32_bf16 v[144:147], v[36:39], v[80:83], v[144:147]
  ds_read_b64_tr_b16 v[56:57], v14 offset:0
  v_mfma_f32_16x16x32_bf16 v[148:151], v[36:39], v[84:87], v[148:151]
  v_mfma_f32_16x16x32_bf16 v[152:155], v[36:39], v[88:91], v[152:155]
  ds_read_b64_tr_b16 v[58:59], v14 offset:512
  v_mfma_f32_16x16x32_bf16 v[156:159], v[36:39], v[92:95], v[156:159]
  v_mfma_f32_16x16x32_bf16 v[160:163], v[40:43], v[80:83], v[160:163]
  ds_read_b64_tr_b16 v[60:61], v15 offset:0
  v_mfma_f32_16x16x32_bf16 v[164:167], v[40:43], v[84:87], v[164:167]
  v_mfma_f32_16x16x32_bf16 v[168:171], v[40:43], v[88:91], v[168:171]
  ds_read_b64_tr_b16 v[62:63], v15 offset:512
  v_mfma_f32_16x16x32_bf16 v[172:175], v[40:43], v[92:95], v[172:175]
  s_waitcnt vmcnt(8) lgkmcnt(0)
  s_barrier
  v_mfma_f32_16x16x32_bf16 v[176:179], v[44:47], v[80:83], v[176:179]
  ds_read_b128 v[64:67], v3 offset:0
  ds_read_b64_tr_b16 v[24:25], v4 offset:0
  v_mfma_f32_16x16x32_bf16 v[180:183], v[44:47], v[84:87], v[180:183]
  ds_read_b64_tr_b16 v[26:27], v4 offset:512
  v_mfma_f32_16x16x32_bf16 v[184:187], v[44:47], v[88:91], v[184:187]
  ds_read_b128 v[68:71], v3 offset:1024
  ds_read_b128 v[72:75], v3 offset:2048
  v_mfma_f32_16x16x32_bf16 v[188:191], v[44:47], v[92:95], v[188:191]
  ds_read_b128 v[76:79], v3 offset:3072
  v_mfma_f32_16x16x32_bf16 v[192:195], v[48:51], v[80:83], v[192:195]
  ds_read_b64_tr_b16 v[28:29], v5 offset:0
  v_mfma_f32_16x16x32_bf16 v[196:199], v[48:51], v[84:87], v[196:199]
  ds_read_b64_tr_b16 v[30:31], v5 offset:512
  ds_read_b64_tr_b16 v[32:33], v6 offset:0
  v_mfma_f32_16x16x32_bf16 v[200:203], v[48:51], v[88:91], v[200:203]
  ds_read_b64_tr_b16 v[34:35], v6 offset:512
  v_mfma_f32_16x16x32_bf16 v[204:207], v[48:51], v[92:95], v[204:207]
  ds_read_b64_tr_b16 v[36:37], v7 offset:0
  v_mfma_f32_16x16x32_bf16 v[208:211], v[52:55], v[80:83], v[208:211]
  ds_read_b64_tr_b16 v[38:39], v7 offset:512
  ds_read_b64_tr_b16 v[40:41], v4 offset:4096
  v_mfma_f32_16x16x32_bf16 v[212:215], v[52:55], v[84:87], v[212:215]
  ds_read_b64_tr_b16 v[42:43], v4 offset:4608
  v_mfma_f32_16x16x32_bf16 v[216:219], v[52:55], v[88:91], v[216:219]
  s_add_u32 m0, s53, 0xc000
  v_mfma_f32_16x16x32_bf16 v[220:223], v[52:55], v[92:95], v[220:223]
  s_add_u32 s56, s56, 0x40
  buffer_load_dwordx4 v1, s[28:31], s56 offen lds
  v_mfma_f32_16x16x32_bf16 v[224:227], v[56:59], v[80:83], v[224:227]
  s_add_u32 m0, s53, 0xe000
  v_mfma_f32_16x16x32_bf16 v[228:231], v[56:59], v[84:87], v[228:231]
  s_add_u32 s57, s57, 0x40
  v_mfma_f32_16x16x32_bf16 v[232:235], v[56:59], v[88:91], v[232:235]
  buffer_load_dwordx4 v1, s[28:31], s57 offen lds
  s_add_u32 m0, s53, 0x1f000
  v_mfma_f32_16x16x32_bf16 v[236:239], v[56:59], v[92:95], v[236:239]
  s_add_u32 s60, s60, s64
  v_mfma_f32_16x16x32_bf16 v[240:243], v[60:63], v[80:83], v[240:243]
  buffer_load_dwordx4 v2, s[32:35], s60 offen lds
  v_mfma_f32_16x16x32_bf16 v[244:247], v[60:63], v[84:87], v[244:247]
  s_add_u32 m0, s53, 0x21000
  s_add_u32 s61, s61, s65
  v_mfma_f32_16x16x32_bf16 v[248:251], v[60:63], v[88:91], v[248:251]
  buffer_load_dwordx4 v22, s[36:39], s61 offen lds
  v_mfma_f32_16x16x32_bf16 v[252:255], v[60:63], v[92:95], v[252:255]
  s_cmp_ge_u32 s52, 4
  s_cbranch_scc1 L_l1_skl3
  s_add_u32 m0, s53, 0x23000
  s_add_u32 s62, s62, s66
  buffer_load_dwordx4 v23, s[40:43], s62 offen lds
L_l1_skl3:
  s_sub_u32 s68, s68, 1
  s_cmp_lg_u32 s68, 0
  s_cbranch_scc1 L_l1_loop
  s_waitcnt lgkmcnt(0)
  v_mfma_f32_16x16x32_bf16 v[96:99], v[24:27], v[64:67], v[96:99]
  ds_read_b64_tr_b16 v[44:45], v5 offset:4096
  v_mfma_f32_16x16x32_bf16 v[100:103], v[24:27], v[68:71], v[100:103]
  v_mfma_f32_16x16x32_bf16 v[104:107], v[24:27], v[72:75], v[104:107]
  ds_read_b64_tr_b16 v[46:47], v5 offset:4608
  v_mfma_f32_16x16x32_bf16 v[108:111], v[24:27], v[76:79], v[108:111]
  v_mfma_f32_16x16x32_bf16 v[112:115], v[28:31], v[64:67], v[112:115]
  ds_read_b64_tr_b16 v[48:49], v6 offset:4096
  v_mfma_f32_16x16x32_bf16 v[116:119], v[28:31], v[68:71], v[116:119]
  v_mfma_f32_16x16x32_bf16 v[120:123], v[28:31], v[72:75], v[120:123]
  ds_read_b64_tr_b16 v[50:51], v6 offset:4608
  v_mfma_f32_16x16x32_bf16 v[124:127], v[28:31], v[76:79], v[124:127]
  v_mfma_f32_16x16x32_bf16 v[128:131], v[32:35], v[64:67], v[128:131]
  ds_read_b64_tr_b16 v[52:53], v7 offset:4096
  v_mfma_f32_16x16x32_bf16 v[132:135], v[32:35], v[68:71], v[132:135]
  v_mfma_f32_16x16x32_bf16 v[136:139], v[32:35], v[72:75], v[136:139]
  ds_read_b64_tr_b16 v[54:55], v7 offset:4608
  v_mfma_f32_16x16x32_bf16 v[140:143], v[32:35], v[76:79], v[140:143]
  v_mfma_f32_16x16x32_bf16 v[144:147], v[36:39], v[64:67], v[144:147]
  ds_read_b64_tr_b16 v[56:57], v8 offset:0
  v_mfma_f32_16x16x32_bf16 v[148:151], v[36:39], v[68:71], v[148:151]
  v_mfma_f32_16x16x32_bf16 v[152:155], v[36:39], v[72:75], v[152:155]
  ds_read_b64_tr_b16 v[58:59], v8 offset:512
  v_mfma_f32_16x16x32_bf16 v[156:159], v[36:39], v[76:79], v[156:159]
  v_mfma_f32_16x16x32_bf16 v[160:163], v[40:43], v[64:67], v[160:163]
  ds_read_b64_tr_b16 v[60:61], v9 offset:0
  v_mfma_f32_16x16x32_bf16 v[164:167], v[40:43], v[68:71], v[164:167]
  v_mfma_f32_16x16x32_bf16 v[168:171], v[40:43], v[72:75], v[168:171]
  ds_read_b64_tr_b16 v[62:63], v9 offset:512
  v_mfma_f32_16x16x32_bf16 v[172:175], v[40:43], v[76:79], v[172:175]
  s_waitcnt vmcnt(8) lgkmcnt(0)
  s_barrier
  v_mfma_f32_16x16x32_bf16 v[176:179], v[44:47], v[64:67], v[176:179]
  ds_read_b128 v[80:83], v3 offset:16384
  v_mfma_f32_16x16x32_bf16 v[180:183], v[44:47], v[68:71], v[180:183]
  ds_read_b64_tr_b16 v[24:25], v4 offset:20480
  v_mfma_f32_16x16x32_bf16 v[184:187], v[44:47], v[72:75], v[184:187]
  ds_read_b64_tr_b16 v[26:27], v4 offset:20992
  v_mfma_f32_16x16x32_bf16 v[188:191], v[44:47], v[76:79], v[188:191]
  v_mfma_f32_16x16x32_bf16 v[192:195], v[48:51], v[64:67], v[192:195]
  ds_read_b128 v[84:87], v3 offset:17408
  v_mfma_f32_16x16x32_bf16 v[196:199], v[48:51], v[68:71], v[196:199]
  ds_read_b128 v[88:91], v3 offset:18432
  v_mfma_f32_16x16x32_bf16 v[200:203], v[48:51], v[72:75], v[200:203]
  v_mfma_f32_16x16x32_bf16 v[204:207], v[48:51], v[76:79], v[204:207]
  ds_read_b128 v[92:95], v3 offset:19456
  v_mfma_f32_16x16x32_bf16 v[208:211], v[52:55], v[64:67], v[208:211]
  ds_read_b64_tr_b16 v[28:29], v5 offset:20480
  v_mfma_f32_16x16x32_bf16 v[212:215], v[52:55], v[68:71], v[212:215]
  v_mfma_f32_16x16x32_bf16 v[216:219], v[52:55], v[72:75], v[216:219]
  ds_read_b64_tr_b16 v[30:31], v5 offset:20992
  v_mfma_f32_16x16x32_bf16 v[220:223], v[52:55], v[76:79], v[220:223]
  ds_read_b64_tr_b16 v[32:33], v6 offset:20480
  v_mfma_f32_16x16x32_bf16 v[224:227], v[56:59], v[64:67], v[224:227]
  ds_read_b64_tr_b16 v[34:35], v6 offset:20992
  v_mfma_f32_16x16x32_bf16 v[228:231], v[56:59], v[68:71], v[228:231]
  v_mfma_f32_16x16x32_bf16 v[232:235], v[56:59], v[72:75], v[232:235]
  ds_read_b64_tr_b16 v[36:37], v7 offset:20480
  v_mfma_f32_16x16x32_bf16 v[236:239], v[56:59], v[76:79], v[236:239]
  ds_read_b64_tr_b16 v[38:39], v7 offset:20992
  v_mfma_f32_16x16x32_bf16 v[240:243], v[60:63], v[64:67], v[240:243]
  v_mfma_f32_16x16x32_bf16 v[244:247], v[60:63], v[68:71], v[244:247]
  ds_read_b64_tr_b16 v[40:41], v4 offset:24576
  v_mfma_f32_16x16x32_bf16 v[248:251], v[60:63], v[72:75], v[248:251]
  ds_read_b64_tr_b16 v[42:43], v4 offset:25088
  v_mfma_f32_16x16x32_bf16 v[252:255], v[60:63], v[76:79], v[252:255]
  s_waitcnt lgkmcnt(0)
  v_mfma_f32_16x16x32_bf16 v[96:99], v[24:27], v[80:83], v[96:99]
  ds_read_b64_tr_b16 v[44:45], v5 offset:24576
  v_mfma_f32_16x16x32_bf16 v[100:103], v[24:27], v[84:87], v[100:103]
  v_mfma_f32_16x16x32_bf16 v[104:107], v[24:27], v[88:91], v[104:107]
  ds_read_b64_tr_b16 v[46:47], v5 offset:25088
  v_mfma_f32_16x16x32_bf16 v[108:111], v[24:27], v[92:95], v[108:111]
  v_mfma_f32_16x16x32_bf16 v[112:115], v[28:31], v[80:83], v[112:115]
  ds_read_b64_tr_b16 v[48:49], v6 offset:24576
  v_mfma_f32_16x16x32_bf16 v[116:119], v[28:31], v[84:87], v[116:119]
  v_mfma_f32_16x16x32_bf16 v[120:123], v[28:31], v[88:91], v[120:123]
  ds_read_b64_tr_b16 v[50:51], v6 offset:25088
  v_mfma_f32_16x16x32_bf16 v[124:127], v[28:31], v[92:95], v[124:127]
  v_mfma_f32_16x16x32_bf16 v[128:131], v[32:35], v[80:83], v[128:131]
  ds_read_b64_tr_b16 v[52:53], v7 offset:24576
  v_mfma_f32_16x16x32_bf16 v[132:135], v[32:35], v[84:87], v[132:135]
  v_mfma_f32_16x16x32_bf16 v[136:139], v[32:35], v[88:91], v[136:139]
  ds_read_b64_tr_b16 v[54:55], v7 offset:25088
  v_mfma_f32_16x16x32_bf16 v[140:143], v[32:35], v[92:95], v[140:143]
  v_mfma_f32_16x16x32_bf16 v[144:147], v[36:39], v[80:83], v[144:147]
  ds_read_b64_tr_b16 v[56:57], v8 offset:20480
  v_mfma_f32_16x16x32_bf16 v[148:151], v[36:39], v[84:87], v[148:151]
  v_mfma_f32_16x16x32_bf16 v[152:155], v[36:39], v[88:91], v[152:155]
  ds_read_b64_tr_b16 v[58:59], v8 offset:20992
  v_mfma_f32_16x16x32_bf16 v[156:159], v[36:39], v[92:95], v[156:159]
  v_mfma_f32_16x16x32_bf16 v[160:163], v[40:43], v[80:83], v[160:163]
  ds_read_b64_tr_b16 v[60:61], v9 offset:20480
  v_mfma_f32_16x16x32_bf16 v[164:167], v[40:43], v[84:87], v[164:167]
  v_mfma_f32_16x16x32_bf16 v[168:171], v[40:43], v[88:91], v[168:171]
  ds_read_b64_tr_b16 v[62:63], v9 offset:20992
  v_mfma_f32_16x16x32_bf16 v[172:175], v[40:43], v[92:95], v[172:175]
  s_waitcnt vmcnt(4) lgkmcnt(0)
  s_barrier
  v_mfma_f32_16x16x32_bf16 v[176:179], v[44:47], v[80:83], v[176:179]
  ds_read_b128 v[64:67], v3 offset:32768
  v_mfma_f32_16x16x32_bf16 v[180:183], v[44:47], v[84:87], v[180:183]
  ds_read_b64_tr_b16 v[24:25], v4 offset:40960
  v_mfma_f32_16x16x32_bf16 v[184:187], v[44:47], v[88:91], v[184:187]
  ds_read_b64_tr_b16 v[26:27], v4 offset:41472
  v_mfma_f32_16x16x32_bf16 v[188:191], v[44:47], v[92:95], v[188:191]
  v_mfma_f32_16x16x32_bf16 v[192:195], v[48:51], v[80:83], v[192:195]
  ds_read_b128 v[68:71], v3 offset:33792
  v_mfma_f32_16x16x32_bf16 v[196:199], v[48:51], v[84:87], v[196:199]
  ds_read_b128 v[72:75], v3 offset:34816
  v_mfma_f32_16x16x32_bf16 v[200:203], v[48:51], v[88:91], v[200:203]
  v_mfma_f32_16x16x32_bf16 v[204:207], v[48:51], v[92:95], v[204:207]
  ds_read_b128 v[76:79], v3 offset:35840
  v_mfma_f32_16x16x32_bf16 v[208:211], v[52:55], v[80:83], v[208:211]
  ds_read_b64_tr_b16 v[28:29], v5 offset:40960
  v_mfma_f32_16x16x32_bf16 v[212:215], v[52:55], v[84:87], v[212:215]
  v_mfma_f32_16x16x32_bf16 v[216:219], v[52:55], v[88:91], v[216:219]
  ds_read_b64_tr_b16 v[30:31], v5 offset:41472
  v_mfma_f32_16x16x32_bf16 v[220:223], v[52:55], v[92:95], v[220:223]
  ds_read_b64_tr_b16 v[32:33], v6 offset:40960
  v_mfma_f32_16x16x32_bf16 v[224:227], v[56:59], v[80:83], v[224:227]
  ds_read_b64_tr_b16 v[34:35], v6 offset:41472
  v_mfma_f32_16x16x32_bf16 v[228:231], v[56:59], v[84:87], v[228:231]
  v_mfma_f32_16x16x32_bf16 v[232:235], v[56:59], v[88:91], v[232:235]
  ds_read_b64_tr_b16 v[36:37], v7 offset:40960
  v_mfma_f32_16x16x32_bf16 v[236:239], v[56:59], v[92:95], v[236:239]
  ds_read_b64_tr_b16 v[38:39], v7 offset:41472
  v_mfma_f32_16x16x32_bf16 v[240:243], v[60:63], v[80:83], v[240:243]
  v_mfma_f32_16x16x32_bf16 v[244:247], v[60:63], v[84:87], v[244:247]
  ds_read_b64_tr_b16 v[40:41], v4 offset:45056
  v_mfma_f32_16x16x32_bf16 v[248:251], v[60:63], v[88:91], v[248:251]
  ds_read_b64_tr_b16 v[42:43], v4 offset:45568
  v_mfma_f32_16x16x32_bf16 v[252:255], v[60:63], v[92:95], v[252:255]
  s_waitcnt lgkmcnt(0)
  v_mfma_f32_16x16x32_bf16 v[96:99], v[24:27], v[64:67], v[96:99]
  ds_read_b64_tr_b16 v[44:45], v5 offset:45056
  v_mfma_f32_16x16x32_bf16 v[100:103], v[24:27], v[68:71], v[100:103]
  v_mfma_f32_16x16x32_bf16 v[104:107], v[24:27], v[72:75], v[104:107]
  ds_read_b64_tr_b16 v[46:47], v5 offset:45568
  v_mfma_f32_16x16x32_bf16 v[108:111], v[24:27], v[76:79], v[108:111]
  v_mfma_f32_16x16x32_bf16 v[112:115], v[28:31], v[64:67], v[112:115]
  ds_read_b64_tr_b16 v[48:49], v6 offset:45056
  v_mfma_f32_16x16x32_bf16 v[116:119], v[28:31], v[68:71], v[116:119]
  v_mfma_f32_16x16x32_bf16 v[120:123], v[28:31], v[72:75], v[120:123]
  ds_read_b64_tr_b16 v[50:51], v6 offset:45568
  v_mfma_f32_16x16x32_bf16 v[124:127], v[28:31], v[76:79], v[124:127]
  v_mfma_f32_16x16x32_bf16 v[128:131], v[32:35], v[64:67], v[128:131]
  ds_read_b64_tr_b16 v[52:53], v7 offset:45056
  v_mfma_f32_16x16x32_bf16 v[132:135], v[32:35], v[68:71], v[132:135]
  v_mfma_f32_16x16x32_bf16 v[136:139], v[32:35], v[72:75], v[136:139]
  ds_read_b64_tr_b16 v[54:55], v7 offset:45568
  v_mfma_f32_16x16x32_bf16 v[140:143], v[32:35], v[76:79], v[140:143]
  v_mfma_f32_16x16x32_bf16 v[144:147], v[36:39], v[64:67], v[144:147]
  ds_read_b64_tr_b16 v[56:57], v8 offset:40960
  v_mfma_f32_16x16x32_bf16 v[148:151], v[36:39], v[68:71], v[148:151]
  v_mfma_f32_16x16x32_bf16 v[152:155], v[36:39], v[72:75], v[152:155]
  ds_read_b64_tr_b16 v[58:59], v8 offset:41472
  v_mfma_f32_16x16x32_bf16 v[156:159], v[36:39], v[76:79], v[156:159]
  v_mfma_f32_16x16x32_bf16 v[160:163], v[40:43], v[64:67], v[160:163]
  ds_read_b64_tr_b16 v[60:61], v9 offset:40960
  v_mfma_f32_16x16x32_bf16 v[164:167], v[40:43], v[68:71], v[164:167]
  v_mfma_f32_16x16x32_bf16 v[168:171], v[40:43], v[72:75], v[168:171]
  ds_read_b64_tr_b16 v[62:63], v9 offset:41472
  v_mfma_f32_16x16x32_bf16 v[172:175], v[40:43], v[76:79], v[172:175]
  s_waitcnt vmcnt(0) lgkmcnt(0)
  s_barrier
  v_mfma_f32_16x16x32_bf16 v[176:179], v[44:47], v[64:67], v[176:179]
  ds_read_b128 v[80:83], v3 offset:49152
  v_mfma_f32_16x16x32_bf16 v[180:183], v[44:47], v[68:71], v[180:183]
  ds_read_b64_tr_b16 v[24:25], v10 offset:0
  v_mfma_f32_16x16x32_bf16 v[184:187], v[44:47], v[72:75], v[184:187]
  ds_read_b64_tr_b16 v[26:27], v10 offset:512
  v_mfma_f32_16x16x32_bf16 v[188:191], v[44:47], v[76:79], v[188:191]
  v_mfma_f32_16x16x32_bf16 v[192:195], v[48:51], v[64:67], v[192:195]
  ds_read_b128 v[84:87], v3 offset:50176
  v_mfma_f32_16x16x32_bf16 v[196:199], v[48:51], v[68:71], v[196:199]
  ds_read_b128 v[88:91], v3 offset:51200
  v_mfma_f32_16x16x32_bf16 v[200:203], v[48:51], v[72:75], v[200:203]
  v_mfma_f32_16x16x32_bf16 v[204:207], v[48:51], v[76:79], v[204:207]
  ds_read_b128 v[92:95], v3 offset:52224
  v_mfma_f32_16x16x32_bf16 v[208:211], v[52:55], v[64:67], v[208:211]
  ds_read_b64_tr_b16 v[28:29], v11 offset:0
  v_mfma_f32_16x16x32_bf16 v[212:215], v[52:55], v[68:71], v[212:215]
  v_mfma_f32_16x16x32_bf16 v[216:219], v[52:55], v[72:75], v[216:219]
  ds_read_b64_tr_b16 v[30:31], v11 offset:512
  v_mfma_f32_16x16x32_bf16 v[220:223], v[52:55], v[76:79], v[220:223]
  ds_read_b64_tr_b16 v[32:33], v12 offset:0
  v_mfma_f32_16x16x32_bf16 v[224:227], v[56:59], v[64:67], v[224:227]
  ds_read_b64_tr_b16 v[34:35], v12 offset:512
  v_mfma_f32_16x16x32_bf16 v[228:231], v[56:59], v[68:71], v[228:231]
  v_mfma_f32_16x16x32_bf16 v[232:235], v[56:59], v[72:75], v[232:235]
  ds_read_b64_tr_b16 v[36:37], v13 offset:0
  v_mfma_f32_16x16x32_bf16 v[236:239], v[56:59], v[76:79], v[236:239]
  ds_read_b64_tr_b16 v[38:39], v13 offset:512
  v_mfma_f32_16x16x32_bf16 v[240:243], v[60:63], v[64:67], v[240:243]
  v_mfma_f32_16x16x32_bf16 v[244:247], v[60:63], v[68:71], v[244:247]
  ds_read_b64_tr_b16 v[40:41], v10 offset:4096
  v_mfma_f32_16x16x32_bf16 v[248:251], v[60:63], v[72:75], v[248:251]
  ds_read_b64_tr_b16 v[42:43], v10 offset:4608
  v_mfma_f32_16x16x32_bf16 v[252:255], v[60:63], v[76:79], v[252:255]
  s_waitcnt lgkmcnt(0)
  v_mfma_f32_16x16x32_bf16 v[96:99], v[24:27], v[80:83], v[96:99]
  ds_read_b64_tr_b16 v[44:45], v11 offset:4096
  v_mfma_f32_16x16x32_bf16 v[100:103], v[24:27], v[84:87], v[100:103]
  v_mfma_f32_16x16x32_bf16 v[104:107], v[24:27], v[88:91], v[104:107]
  ds_read_b64_tr_b16 v[46:47], v11 offset:4608
  v_mfma_f32_16x16x32_bf16 v[108:111], v[24:27], v[92:95], v[108:111]
  v_mfma_f32_16x16x32_bf16 v[112:115], v[28:31], v[80:83], v[112:115]
  ds_read_b64_tr_b16 v[48:49], v12 offset:4096
  v_mfma_f32_16x16x32_bf16 v[116:119], v[28:31], v[84:87], v[116:119]
  v_mfma_f32_16x16x32_bf16 v[120:123], v[28:31], v[88:91], v[120:123]
  ds_read_b64_tr_b16 v[50:51], v12 offset:4608
  v_mfma_f32_16x16x32_bf16 v[124:127], v[28:31], v[92:95], v[124:127]
  v_mfma_f32_16x16x32_bf16 v[128:131], v[32:35], v[80:83], v[128:131]
  ds_read_b64_tr_b16 v[52:53], v13 offset:4096
  v_mfma_f32_16x16x32_bf16 v[132:135], v[32:35], v[84:87], v[132:135]
  v_mfma_f32_16x16x32_bf16 v[136:139], v[32:35], v[88:91], v[136:139]
  ds_read_b64_tr_b16 v[54:55], v13 offset:4608
  v_mfma_f32_16x16x32_bf16 v[140:143], v[32:35], v[92:95], v[140:143]
  v_mfma_f32_16x16x32_bf16 v[144:147], v[36:39], v[80:83], v[144:147]
  ds_read_b64_tr_b16 v[56:57], v14 offset:0
  v_mfma_f32_16x16x32_bf16 v[148:151], v[36:39], v[84:87], v[148:151]
  v_mfma_f32_16x16x32_bf16 v[152:155], v[36:39], v[88:91], v[152:155]
  ds_read_b64_tr_b16 v[58:59], v14 offset:512
  v_mfma_f32_16x16x32_bf16 v[156:159], v[36:39], v[92:95], v[156:159]
  v_mfma_f32_16x16x32_bf16 v[160:163], v[40:43], v[80:83], v[160:163]
  ds_read_b64_tr_b16 v[60:61], v15 offset:0
  v_mfma_f32_16x16x32_bf16 v[164:167], v[40:43], v[84:87], v[164:167]
  v_mfma_f32_16x16x32_bf16 v[168:171], v[40:43], v[88:91], v[168:171]
  ds_read_b64_tr_b16 v[62:63], v15 offset:512
  v_mfma_f32_16x16x32_bf16 v[172:175], v[40:43], v[92:95], v[172:175]
  s_waitcnt lgkmcnt(0)
  v_mfma_f32_16x16x32_bf16 v[176:179], v[44:47], v[80:83], v[176:179]
  v_mfma_f32_16x16x32_bf16 v[180:183], v[44:47], v[84:87], v[180:183]
  v_mfma_f32_16x16x32_bf16 v[184:187], v[44:47], v[88:91], v[184:187]
  v_mfma_f32_16x16x32_bf16 v[188:191], v[44:47], v[92:95], v[188:191]
  v_mfma_f32_16x16x32_bf16 v[192:195], v[48:51], v[80:83], v[192:195]
  v_mfma_f32_16x16x32_bf16 v[196:199], v[48:51], v[84:87], v[196:199]
  v_mfma_f32_16x16x32_bf16 v[200:203], v[48:51], v[88:91], v[200:203]
  v_mfma_f32_16x16x32_bf16 v[204:207], v[48:51], v[92:95], v[204:207]
  v_mfma_f32_16x16x32_bf16 v[208:211], v[52:55], v[80:83], v[208:211]
  v_mfma_f32_16x16x32_bf16 v[212:215], v[52:55], v[84:87], v[212:215]
  v_mfma_f32_16x16x32_bf16 v[216:219], v[52:55], v[88:91], v[216:219]
  v_mfma_f32_16x16x32_bf16 v[220:223], v[52:55], v[92:95], v[220:223]
  v_mfma_f32_16x16x32_bf16 v[224:227], v[56:59], v[80:83], v[224:227]
  v_mfma_f32_16x16x32_bf16 v[228:231], v[56:59], v[84:87], v[228:231]
  v_mfma_f32_16x16x32_bf16 v[232:235], v[56:59], v[88:91], v[232:235]
  v_mfma_f32_16x16x32_bf16 v[236:239], v[56:59], v[92:95], v[236:239]
  v_mfma_f32_16x16x32_bf16 v[240:243], v[60:63], v[80:83], v[240:243]
  v_mfma_f32_16x16x32_bf16 v[244:247], v[60:63], v[84:87], v[244:247]
  v_mfma_f32_16x16x32_bf16 v[248:251], v[60:63], v[88:91], v[248:251]
  v_mfma_f32_16x16x32_bf16 v[252:255], v[60:63], v[92:95], v[252:255]
  s_nop 15
  s_nop 3
  v_lshlrev_b32 v68, 6, v0
  s_lshl_b32 s100, s2, 3
  s_add_u32 s100, s100, s52
  s_lshl_b32 s100, s100, 12
  s_mov_b32 s48, s16
  s_mov_b32 s49, s17
  s_mov_b32 s50, 0x700000
  s_mov_b32 s51, 0x00020000
  buffer_load_dword v64, v68, s[48:51], s100 offen
  s_mov_b32 s48, s8
  s_mov_b32 s49, s9
  s_mov_b32 s50, 0x200000
  s_mov_b32 s51, 0x00020000
  buffer_load_dword v64, v68, s[48:51], s100 offen
  v_and_b32 v16, 15, v0
  v_lshrrev_b32 v17, 4, v0
  v_and_b32 v18, 1, v17
  v_lshlrev_b32 v18, 5, v18
  v_lshrrev_b32 v17, 1, v17
  v_lshl_add_u32 v17, v17, 4, v18
  s_lshl_b32 s96, s55, 6
  v_add_u32 v20, s96, v16
  v_lshl_add_u32 v18, v20, 6, v17
  s_and_b32 s96, s71, s54
  s_cmp_lg_u32 s96, 0
  s_cbranch_scc1 L_l1_epiQ
  s_lshl_b32 s100, s54, 5
  s_lshl_b32 s96, s71, 7
  s_add_u32 s100, s100, s96
  s_add_u32 s100, s100, s59
  s_lshl_b32 s96, s100, 12
  s_lshl_b32 s97, s69, 6
  s_add_u32 s96, s96, s97
  s_cmp_lt_u32 s100, 1024
  s_cselect_b32 s98, 0x3e8293ee, 1.0
  v_mul_f32 v224, s98, v224
  v_mul_f32 v225, s98, v225
  v_mul_f32 v226, s98, v226
  v_mul_f32 v227, s98, v227
  v_mul_f32 v240, s98, v240
  v_mul_f32 v241, s98, v241
  v_mul_f32 v242, s98, v242
  v_mul_f32 v243, s98, v243
  v_cvt_pk_bf16_f32 v24, v224, v225
  v_cvt_pk_bf16_f32 v25, v226, v227
  v_cvt_pk_bf16_f32 v26, v240, v241
  v_cvt_pk_bf16_f32 v27, v242, v243
  s_nop 1
  v_permlane16_swap_b32 v24, v26
  v_permlane16_swap_b32 v25, v27
  buffer_store_dwordx4 v[24:27], v18, s[44:47], s96 offen offset:0 sc1
  v_mul_f32 v228, s98, v228
  v_mul_f32 v229, s98, v229
  v_mul_f32 v230, s98, v230
  v_mul_f32 v231, s98, v231
  v_mul_f32 v244, s98, v244
  v_mul_f32 v245, s98, v245
  v_mul_f32 v246, s98, v246
  v_mul_f32 v247, s98, v247
  v_cvt_pk_bf16_f32 v28, v228, v229
  v_cvt_pk_bf16_f32 v29, v230, v231
  v_cvt_pk_bf16_f32 v30, v244, v245
  v_cvt_pk_bf16_f32 v31, v246, v247
  s_nop 1
  v_permlane16_swap_b32 v28, v30
  v_permlane16_swap_b32 v29, v31
  buffer_store_dwordx4 v[28:31], v18, s[44:47], s96 offen offset:1024 sc1
  v_mul_f32 v232, s98, v232
  v_mul_f32 v233, s98, v233
  v_mul_f32 v234, s98, v234
  v_mul_f32 v235, s98, v235
  v_mul_f32 v248, s98, v248
  v_mul_f32 v249, s98, v249
  v_mul_f32 v250, s98, v250
  v_mul_f32 v251, s98, v251
  v_cvt_pk_bf16_f32 v32, v232, v233
  v_cvt_pk_bf16_f32 v33, v234, v235
  v_cvt_pk_bf16_f32 v34, v248, v249
  v_cvt_pk_bf16_f32 v35, v250, v251
  s_nop 1
  v_permlane16_swap_b32 v32, v34
  v_permlane16_swap_b32 v33, v35
  buffer_store_dwordx4 v[32:35], v18, s[44:47], s96 offen offset:2048 sc1
  v_mul_f32 v236, s98, v236
  v_mul_f32 v237, s98, v237
  v_mul_f32 v238, s98, v238
  v_mul_f32 v239, s98, v239
  v_mul_f32 v252, s98, v252
  v_mul_f32 v253, s98, v253
  v_mul_f32 v254, s98, v254
  v_mul_f32 v255, s98, v255
  v_cvt_pk_bf16_f32 v36, v236, v237
  v_cvt_pk_bf16_f32 v37, v238, v239
  v_cvt_pk_bf16_f32 v38, v252, v253
  v_cvt_pk_bf16_f32 v39, v254, v255
  s_nop 1
  v_permlane16_swap_b32 v36, v38
  v_permlane16_swap_b32 v37, v39
  buffer_store_dwordx4 v[36:39], v18, s[44:47], s96 offen offset:3072 sc1
  s_cmp_lg_u32 s54, 0
  s_cselect_b32 s97, s58, s70
  s_lshl_b32 s97, s97, 12
  s_lshl_b32 s96, s69, 6
  s_add_u32 s96, s96, s97
  s_add_u32 s96, s96, 0xc00000
  s_mov_b32 s100, 0x3dd2d3e8
  s_mov_b32 s101, 0x3dd2d3e8
  v_mov_b32 v80, 0x40135761
  v_mov_b32 v81, 0x40135761
  s_add_u32 s99, s96, 0x0
  s_add_u32 s98, s99, 0x20000
  v_pk_mul_f32 v[160:161], v[96:97], v[160:161]
  v_pk_mul_f32 v[162:163], v[98:99], v[162:163]
  v_pk_mul_f32 v[176:177], v[112:113], v[176:177]
  v_pk_mul_f32 v[178:179], v[114:115], v[178:179]
  v_pk_mul_f32 v[192:193], v[128:129], v[192:193]
  v_pk_mul_f32 v[194:195], v[130:131], v[194:195]
  v_pk_mul_f32 v[208:209], v[144:145], v[208:209]
  v_pk_mul_f32 v[210:211], v[146:147], v[210:211]
  v_pk_mul_f32 v[72:73], v[96:97], v[96:97]
  v_pk_fma_f32 v[72:73], v[72:73], s[100:101], v[80:81] op_sel_hi:[1,0,1]
  v_pk_mul_f32 v[96:97], v[96:97], v[72:73]
  v_pk_mul_f32 v[74:75], v[98:99], v[98:99]
  v_pk_fma_f32 v[74:75], v[74:75], s[100:101], v[80:81] op_sel_hi:[1,0,1]
  v_pk_mul_f32 v[98:99], v[98:99], v[74:75]
  v_pk_mul_f32 v[76:77], v[112:113], v[112:113]
  v_pk_fma_f32 v[76:77], v[76:77], s[100:101], v[80:81] op_sel_hi:[1,0,1]
  v_pk_mul_f32 v[112:113], v[112:113], v[76:77]
  v_pk_mul_f32 v[78:79], v[114:115], v[114:115]
  v_pk_fma_f32 v[78:79], v[78:79], s[100:101], v[80:81] op_sel_hi:[1,0,1]
  v_pk_mul_f32 v[114:115], v[114:115], v[78:79]
  v_pk_mul_f32 v[72:73], v[128:129], v[128:129]
  v_pk_fma_f32 v[72:73], v[72:73], s[100:101], v[80:81] op_sel_hi:[1,0,1]
  v_pk_mul_f32 v[128:129], v[128:129], v[72:73]
  v_pk_mul_f32 v[74:75], v[130:131], v[130:131]
  v_pk_fma_f32 v[74:75], v[74:75], s[100:101], v[80:81] op_sel_hi:[1,0,1]
  v_pk_mul_f32 v[130:131], v[130:131], v[74:75]
  v_pk_mul_f32 v[76:77], v[144:145], v[144:145]
  v_pk_fma_f32 v[76:77], v[76:77], s[100:101], v[80:81] op_sel_hi:[1,0,1]
  v_pk_mul_f32 v[144:145], v[144:145], v[76:77]
  v_pk_mul_f32 v[78:79], v[146:147], v[146:147]
  v_pk_fma_f32 v[78:79], v[78:79], s[100:101], v[80:81] op_sel_hi:[1,0,1]
  v_pk_mul_f32 v[146:147], v[146:147], v[78:79]
  v_exp_f32 v96, -v96
  v_exp_f32 v97, -v97
  v_exp_f32 v98, -v98
  v_exp_f32 v99, -v99
  v_exp_f32 v112, -v112
  v_exp_f32 v113, -v113
  v_exp_f32 v114, -v114
  v_exp_f32 v115, -v115
  v_exp_f32 v128, -v128
  v_exp_f32 v129, -v129
  v_exp_f32 v130, -v130
  v_exp_f32 v131, -v131
  v_exp_f32 v144, -v144
  v_exp_f32 v145, -v145
  v_exp_f32 v146, -v146
  v_exp_f32 v147, -v147
  v_pk_add_f32 v[96:97], v[96:97], 1.0 op_sel_hi:[1,0]
  v_pk_add_f32 v[98:99], v[98:99], 1.0 op_sel_hi:[1,0]
  v_pk_add_f32 v[112:113], v[112:113], 1.0 op_sel_hi:[1,0]
  v_pk_add_f32 v[114:115], v[114:115], 1.0 op_sel_hi:[1,0]
  v_pk_add_f32 v[128:129], v[128:129], 1.0 op_sel_hi:[1,0]
  v_pk_add_f32 v[130:131], v[130:131], 1.0 op_sel_hi:[1,0]
  v_pk_add_f32 v[144:145], v[144:145], 1.0 op_sel_hi:[1,0]
  v_pk_add_f32 v[146:147], v[146:147], 1.0 op_sel_hi:[1,0]
  v_rcp_f32 v96, v96
  v_rcp_f32 v97, v97
  v_rcp_f32 v98, v98
  v_rcp_f32 v99, v99
  v_rcp_f32 v112, v112
  v_rcp_f32 v113, v113
  v_rcp_f32 v114, v114
  v_rcp_f32 v115, v115
  v_rcp_f32 v128, v128
  v_rcp_f32 v129, v129
  v_rcp_f32 v130, v130
  v_rcp_f32 v131, v131
  v_rcp_f32 v144, v144
  v_rcp_f32 v145, v145
  v_rcp_f32 v146, v146
  v_rcp_f32 v147, v147
  v_pk_mul_f32 v[160:161], v[160:161], v[96:97]
  v_pk_mul_f32 v[162:163], v[162:163], v[98:99]
  v_pk_mul_f32 v[176:177], v[176:177], v[112:113]
  v_pk_mul_f32 v[178:179], v[178:179], v[114:115]
  v_pk_mul_f32 v[192:193], v[192:193], v[128:129]
  v_pk_mul_f32 v[194:195], v[194:195], v[130:131]
  v_pk_mul_f32 v[208:209], v[208:209], v[144:145]
  v_pk_mul_f32 v[210:211], v[210:211], v[146:147]
  v_cvt_pk_bf16_f32 v40, v160, v161
  v_cvt_pk_bf16_f32 v41, v162, v163
  v_cvt_pk_bf16_f32 v42, v176, v177
  v_cvt_pk_bf16_f32 v43, v178, v179
  s_nop 1
  v_permlane16_swap_b32 v40, v42
  v_permlane16_swap_b32 v41, v43
  buffer_store_dwordx4 v[40:43], v18, s[44:47], s99 offen offset:0 sc1
  v_cvt_pk_bf16_f32 v44, v192, v193
  v_cvt_pk_bf16_f32 v45, v194, v195
  v_cvt_pk_bf16_f32 v46, v208, v209
  v_cvt_pk_bf16_f32 v47, v210, v211
  s_nop 1
  v_permlane16_swap_b32 v44, v46
  v_permlane16_swap_b32 v45, v47
  buffer_store_dwordx4 v[44:47], v18, s[44:47], s98 offen offset:0 sc1
  s_add_u32 s99, s96, 0x400
  s_add_u32 s98, s99, 0x20000
  v_pk_mul_f32 v[164:165], v[100:101], v[164:165]
  v_pk_mul_f32 v[166:167], v[102:103], v[166:167]
  v_pk_mul_f32 v[180:181], v[116:117], v[180:181]
  v_pk_mul_f32 v[182:183], v[118:119], v[182:183]
  v_pk_mul_f32 v[196:197], v[132:133], v[196:197]
  v_pk_mul_f32 v[198:199], v[134:135], v[198:199]
  v_pk_mul_f32 v[212:213], v[148:149], v[212:213]
  v_pk_mul_f32 v[214:215], v[150:151], v[214:215]
  v_pk_mul_f32 v[72:73], v[100:101], v[100:101]
  v_pk_fma_f32 v[72:73], v[72:73], s[100:101], v[80:81] op_sel_hi:[1,0,1]
  v_pk_mul_f32 v[100:101], v[100:101], v[72:73]
  v_pk_mul_f32 v[74:75], v[102:103], v[102:103]
  v_pk_fma_f32 v[74:75], v[74:75], s[100:101], v[80:81] op_sel_hi:[1,0,1]
  v_pk_mul_f32 v[102:103], v[102:103], v[74:75]
  v_pk_mul_f32 v[76:77], v[116:117], v[116:117]
  v_pk_fma_f32 v[76:77], v[76:77], s[100:101], v[80:81] op_sel_hi:[1,0,1]
  v_pk_mul_f32 v[116:117], v[116:117], v[76:77]
  v_pk_mul_f32 v[78:79], v[118:119], v[118:119]
  v_pk_fma_f32 v[78:79], v[78:79], s[100:101], v[80:81] op_sel_hi:[1,0,1]
  v_pk_mul_f32 v[118:119], v[118:119], v[78:79]
  v_pk_mul_f32 v[72:73], v[132:133], v[132:133]
  v_pk_fma_f32 v[72:73], v[72:73], s[100:101], v[80:81] op_sel_hi:[1,0,1]
  v_pk_mul_f32 v[132:133], v[132:133], v[72:73]
  v_pk_mul_f32 v[74:75], v[134:135], v[134:135]
  v_pk_fma_f32 v[74:75], v[74:75], s[100:101], v[80:81] op_sel_hi:[1,0,1]
  v_pk_mul_f32 v[134:135], v[134:135], v[74:75]
  v_pk_mul_f32 v[76:77], v[148:149], v[148:149]
  v_pk_fma_f32 v[76:77], v[76:77], s[100:101], v[80:81] op_sel_hi:[1,0,1]
  v_pk_mul_f32 v[148:149], v[148:149], v[76:77]
  v_pk_mul_f32 v[78:79], v[150:151], v[150:151]
  v_pk_fma_f32 v[78:79], v[78:79], s[100:101], v[80:81] op_sel_hi:[1,0,1]
  v_pk_mul_f32 v[150:151], v[150:151], v[78:79]
  v_exp_f32 v100, -v100
  v_exp_f32 v101, -v101
  v_exp_f32 v102, -v102
  v_exp_f32 v103, -v103
  v_exp_f32 v116, -v116
  v_exp_f32 v117, -v117
  v_exp_f32 v118, -v118
  v_exp_f32 v119, -v119
  v_exp_f32 v132, -v132
  v_exp_f32 v133, -v133
  v_exp_f32 v134, -v134
  v_exp_f32 v135, -v135
  v_exp_f32 v148, -v148
  v_exp_f32 v149, -v149
  v_exp_f32 v150, -v150
  v_exp_f32 v151, -v151
  v_pk_add_f32 v[100:101], v[100:101], 1.0 op_sel_hi:[1,0]
  v_pk_add_f32 v[102:103], v[102:103], 1.0 op_sel_hi:[1,0]
  v_pk_add_f32 v[116:117], v[116:117], 1.0 op_sel_hi:[1,0]
  v_pk_add_f32 v[118:119], v[118:119], 1.0 op_sel_hi:[1,0]
  v_pk_add_f32 v[132:133], v[132:133], 1.0 op_sel_hi:[1,0]
  v_pk_add_f32 v[134:135], v[134:135], 1.0 op_sel_hi:[1,0]
  v_pk_add_f32 v[148:149], v[148:149], 1.0 op_sel_hi:[1,0]
  v_pk_add_f32 v[150:151], v[150:151], 1.0 op_sel_hi:[1,0]
  v_rcp_f32 v100, v100
  v_rcp_f32 v101, v101
  v_rcp_f32 v102, v102
  v_rcp_f32 v103, v103
  v_rcp_f32 v116, v116
  v_rcp_f32 v117, v117
  v_rcp_f32 v118, v118
  v_rcp_f32 v119, v119
  v_rcp_f32 v132, v132
  v_rcp_f32 v133, v133
  v_rcp_f32 v134, v134
  v_rcp_f32 v135, v135
  v_rcp_f32 v148, v148
  v_rcp_f32 v149, v149
  v_rcp_f32 v150, v150
  v_rcp_f32 v151, v151
  v_pk_mul_f32 v[164:165], v[164:165], v[100:101]
  v_pk_mul_f32 v[166:167], v[166:167], v[102:103]
  v_pk_mul_f32 v[180:181], v[180:181], v[116:117]
  v_pk_mul_f32 v[182:183], v[182:183], v[118:119]
  v_pk_mul_f32 v[196:197], v[196:197], v[132:133]
  v_pk_mul_f32 v[198:199], v[198:199], v[134:135]
  v_pk_mul_f32 v[212:213], v[212:213], v[148:149]
  v_pk_mul_f32 v[214:215], v[214:215], v[150:151]
  v_cvt_pk_bf16_f32 v24, v164, v165
  v_cvt_pk_bf16_f32 v25, v166, v167
  v_cvt_pk_bf16_f32 v26, v180, v181
  v_cvt_pk_bf16_f32 v27, v182, v183
  s_nop 1
  v_permlane16_swap_b32 v24, v26
  v_permlane16_swap_b32 v25, v27
  buffer_store_dwordx4 v[24:27], v18, s[44:47], s99 offen offset:0 sc1
  v_cvt_pk_bf16_f32 v28, v196, v197
  v_cvt_pk_bf16_f32 v29, v198, v199
  v_cvt_pk_bf16_f32 v30, v212, v213
  v_cvt_pk_bf16_f32 v31, v214, v215
  s_nop 1
  v_permlane16_swap_b32 v28, v30
  v_permlane16_swap_b32 v29, v31
  buffer_store_dwordx4 v[28:31], v18, s[44:47], s98 offen offset:0 sc1
  s_add_u32 s99, s96, 0x800
  s_add_u32 s98, s99, 0x20000
  v_pk_mul_f32 v[168:169], v[104:105], v[168:169]
  v_pk_mul_f32 v[170:171], v[106:107], v[170:171]
  v_pk_mul_f32 v[184:185], v[120:121], v[184:185]
  v_pk_mul_f32 v[186:187], v[122:123], v[186:187]
  v_pk_mul_f32 v[200:201], v[136:137], v[200:201]
  v_pk_mul_f32 v[202:203], v[138:139], v[202:203]
  v_pk_mul_f32 v[216:217], v[152:153], v[216:217]
  v_pk_mul_f32 v[218:219], v[154:155], v[218:219]
  v_pk_mul_f32 v[72:73], v[104:105], v[104:105]
  v_pk_fma_f32 v[72:73], v[72:73], s[100:101], v[80:81] op_sel_hi:[1,0,1]
  v_pk_mul_f32 v[104:105], v[104:105], v[72:73]
  v_pk_mul_f32 v[74:75], v[106:107], v[106:107]
  v_pk_fma_f32 v[74:75], v[74:75], s[100:101], v[80:81] op_sel_hi:[1,0,1]
  v_pk_mul_f32 v[106:107], v[106:107], v[74:75]
  v_pk_mul_f32 v[76:77], v[120:121], v[120:121]
  v_pk_fma_f32 v[76:77], v[76:77], s[100:101], v[80:81] op_sel_hi:[1,0,1]
  v_pk_mul_f32 v[120:121], v[120:121], v[76:77]
  v_pk_mul_f32 v[78:79], v[122:123], v[122:123]
  v_pk_fma_f32 v[78:79], v[78:79], s[100:101], v[80:81] op_sel_hi:[1,0,1]
  v_pk_mul_f32 v[122:123], v[122:123], v[78:79]
  v_pk_mul_f32 v[72:73], v[136:137], v[136:137]
  v_pk_fma_f32 v[72:73], v[72:73], s[100:101], v[80:81] op_sel_hi:[1,0,1]
  v_pk_mul_f32 v[136:137], v[136:137], v[72:73]
  v_pk_mul_f32 v[74:75], v[138:139], v[138:139]
  v_pk_fma_f32 v[74:75], v[74:75], s[100:101], v[80:81] op_sel_hi:[1,0,1]
  v_pk_mul_f32 v[138:139], v[138:139], v[74:75]
  v_pk_mul_f32 v[76:77], v[152:153], v[152:153]
  v_pk_fma_f32 v[76:77], v[76:77], s[100:101], v[80:81] op_sel_hi:[1,0,1]
  v_pk_mul_f32 v[152:153], v[152:153], v[76:77]
  v_pk_mul_f32 v[78:79], v[154:155], v[154:155]
  v_pk_fma_f32 v[78:79], v[78:79], s[100:101], v[80:81] op_sel_hi:[1,0,1]
  v_pk_mul_f32 v[154:155], v[154:155], v[78:79]
  v_exp_f32 v104, -v104
  v_exp_f32 v105, -v105
  v_exp_f32 v106, -v106
  v_exp_f32 v107, -v107
  v_exp_f32 v120, -v120
  v_exp_f32 v121, -v121
  v_exp_f32 v122, -v122
  v_exp_f32 v123, -v123
  v_exp_f32 v136, -v136
  v_exp_f32 v137, -v137
  v_exp_f32 v138, -v138
  v_exp_f32 v139, -v139
  v_exp_f32 v152, -v152
  v_exp_f32 v153, -v153
  v_exp_f32 v154, -v154
  v_exp_f32 v155, -v155
  v_pk_add_f32 v[104:105], v[104:105], 1.0 op_sel_hi:[1,0]
  v_pk_add_f32 v[106:107], v[106:107], 1.0 op_sel_hi:[1,0]
  v_pk_add_f32 v[120:121], v[120:121], 1.0 op_sel_hi:[1,0]
  v_pk_add_f32 v[122:123], v[122:123], 1.0 op_sel_hi:[1,0]
  v_pk_add_f32 v[136:137], v[136:137], 1.0 op_sel_hi:[1,0]
  v_pk_add_f32 v[138:139], v[138:139], 1.0 op_sel_hi:[1,0]
  v_pk_add_f32 v[152:153], v[152:153], 1.0 op_sel_hi:[1,0]
  v_pk_add_f32 v[154:155], v[154:155], 1.0 op_sel_hi:[1,0]
  v_rcp_f32 v104, v104
  v_rcp_f32 v105, v105
  v_rcp_f32 v106, v106
  v_rcp_f32 v107, v107
  v_rcp_f32 v120, v120
  v_rcp_f32 v121, v121
  v_rcp_f32 v122, v122
  v_rcp_f32 v123, v123
  v_rcp_f32 v136, v136
  v_rcp_f32 v137, v137
  v_rcp_f32 v138, v138
  v_rcp_f32 v139, v139
  v_rcp_f32 v152, v152
  v_rcp_f32 v153, v153
  v_rcp_f32 v154, v154
  v_rcp_f32 v155, v155
  v_pk_mul_f32 v[168:169], v[168:169], v[104:105]
  v_pk_mul_f32 v[170:171], v[170:171], v[106:107]
  v_pk_mul_f32 v[184:185], v[184:185], v[120:121]
  v_pk_mul_f32 v[186:187], v[186:187], v[122:123]
  v_pk_mul_f32 v[200:201], v[200:201], v[136:137]
  v_pk_mul_f32 v[202:203], v[202:203], v[138:139]
  v_pk_mul_f32 v[216:217], v[216:217], v[152:153]
  v_pk_mul_f32 v[218:219], v[218:219], v[154:155]
  v_cvt_pk_bf16_f32 v32, v168, v169
  v_cvt_pk_bf16_f32 v33, v170, v171
  v_cvt_pk_bf16_f32 v34, v184, v185
  v_cvt_pk_bf16_f32 v35, v186, v187
  s_nop 1
  v_permlane16_swap_b32 v32, v34
  v_permlane16_swap_b32 v33, v35
  buffer_store_dwordx4 v[32:35], v18, s[44:47], s99 offen offset:0 sc1
  v_cvt_pk_bf16_f32 v36, v200, v201
  v_cvt_pk_bf16_f32 v37, v202, v203
  v_cvt_pk_bf16_f32 v38, v216, v217
  v_cvt_pk_bf16_f32 v39, v218, v219
  s_nop 1
  v_permlane16_swap_b32 v36, v38
  v_permlane16_swap_b32 v37, v39
  buffer_store_dwordx4 v[36:39], v18, s[44:47], s98 offen offset:0 sc1
  s_add_u32 s99, s96, 0xc00
  s_add_u32 s98, s99, 0x20000
  v_pk_mul_f32 v[172:173], v[108:109], v[172:173]
  v_pk_mul_f32 v[174:175], v[110:111], v[174:175]
  v_pk_mul_f32 v[188:189], v[124:125], v[188:189]
  v_pk_mul_f32 v[190:191], v[126:127], v[190:191]
  v_pk_mul_f32 v[204:205], v[140:141], v[204:205]
  v_pk_mul_f32 v[206:207], v[142:143], v[206:207]
  v_pk_mul_f32 v[220:221], v[156:157], v[220:221]
  v_pk_mul_f32 v[222:223], v[158:159], v[222:223]
  v_pk_mul_f32 v[72:73], v[108:109], v[108:109]
  v_pk_fma_f32 v[72:73], v[72:73], s[100:101], v[80:81] op_sel_hi:[1,0,1]
  v_pk_mul_f32 v[108:109], v[108:109], v[72:73]
  v_pk_mul_f32 v[74:75], v[110:111], v[110:111]
  v_pk_fma_f32 v[74:75], v[74:75], s[100:101], v[80:81] op_sel_hi:[1,0,1]
  v_pk_mul_f32 v[110:111], v[110:111], v[74:75]
  v_pk_mul_f32 v[76:77], v[124:125], v[124:125]
  v_pk_fma_f32 v[76:77], v[76:77], s[100:101], v[80:81] op_sel_hi:[1,0,1]
  v_pk_mul_f32 v[124:125], v[124:125], v[76:77]
  v_pk_mul_f32 v[78:79], v[126:127], v[126:127]
  v_pk_fma_f32 v[78:79], v[78:79], s[100:101], v[80:81] op_sel_hi:[1,0,1]
  v_pk_mul_f32 v[126:127], v[126:127], v[78:79]
  v_pk_mul_f32 v[72:73], v[140:141], v[140:141]
  v_pk_fma_f32 v[72:73], v[72:73], s[100:101], v[80:81] op_sel_hi:[1,0,1]
  v_pk_mul_f32 v[140:141], v[140:141], v[72:73]
  v_pk_mul_f32 v[74:75], v[142:143], v[142:143]
  v_pk_fma_f32 v[74:75], v[74:75], s[100:101], v[80:81] op_sel_hi:[1,0,1]
  v_pk_mul_f32 v[142:143], v[142:143], v[74:75]
  v_pk_mul_f32 v[76:77], v[156:157], v[156:157]
  v_pk_fma_f32 v[76:77], v[76:77], s[100:101], v[80:81] op_sel_hi:[1,0,1]
  v_pk_mul_f32 v[156:157], v[156:157], v[76:77]
  v_pk_mul_f32 v[78:79], v[158:159], v[158:159]
  v_pk_fma_f32 v[78:79], v[78:79], s[100:101], v[80:81] op_sel_hi:[1,0,1]
  v_pk_mul_f32 v[158:159], v[158:159], v[78:79]
  v_exp_f32 v108, -v108
  v_exp_f32 v109, -v109
  v_exp_f32 v110, -v110
  v_exp_f32 v111, -v111
  v_exp_f32 v124, -v124
  v_exp_f32 v125, -v125
  v_exp_f32 v126, -v126
  v_exp_f32 v127, -v127
  v_exp_f32 v140, -v140
  v_exp_f32 v141, -v141
  v_exp_f32 v142, -v142
  v_exp_f32 v143, -v143
  v_exp_f32 v156, -v156
  v_exp_f32 v157, -v157
  v_exp_f32 v158, -v158
  v_exp_f32 v159, -v159
  v_pk_add_f32 v[108:109], v[108:109], 1.0 op_sel_hi:[1,0]
  v_pk_add_f32 v[110:111], v[110:111], 1.0 op_sel_hi:[1,0]
  v_pk_add_f32 v[124:125], v[124:125], 1.0 op_sel_hi:[1,0]
  v_pk_add_f32 v[126:127], v[126:127], 1.0 op_sel_hi:[1,0]
  v_pk_add_f32 v[140:141], v[140:141], 1.0 op_sel_hi:[1,0]
  v_pk_add_f32 v[142:143], v[142:143], 1.0 op_sel_hi:[1,0]
  v_pk_add_f32 v[156:157], v[156:157], 1.0 op_sel_hi:[1,0]
  v_pk_add_f32 v[158:159], v[158:159], 1.0 op_sel_hi:[1,0]
  v_rcp_f32 v108, v108
  v_rcp_f32 v109, v109
  v_rcp_f32 v110, v110
  v_rcp_f32 v111, v111
  v_rcp_f32 v124, v124
  v_rcp_f32 v125, v125
  v_rcp_f32 v126, v126
  v_rcp_f32 v127, v127
  v_rcp_f32 v140, v140
  v_rcp_f32 v141, v141
  v_rcp_f32 v142, v142
  v_rcp_f32 v143, v143
  v_rcp_f32 v156, v156
  v_rcp_f32 v157, v157
  v_rcp_f32 v158, v158
  v_rcp_f32 v159, v159
  v_pk_mul_f32 v[172:173], v[172:173], v[108:109]
  v_pk_mul_f32 v[174:175], v[174:175], v[110:111]
  v_pk_mul_f32 v[188:189], v[188:189], v[124:125]
  v_pk_mul_f32 v[190:191], v[190:191], v[126:127]
  v_pk_mul_f32 v[204:205], v[204:205], v[140:141]
  v_pk_mul_f32 v[206:207], v[206:207], v[142:143]
  v_pk_mul_f32 v[220:221], v[220:221], v[156:157]
  v_pk_mul_f32 v[222:223], v[222:223], v[158:159]
  v_cvt_pk_bf16_f32 v40, v172, v173
  v_cvt_pk_bf16_f32 v41, v174, v175
  v_cvt_pk_bf16_f32 v42, v188, v189
  v_cvt_pk_bf16_f32 v43, v190, v191
  s_nop 1
  v_permlane16_swap_b32 v40, v42
  v_permlane16_swap_b32 v41, v43
  buffer_store_dwordx4 v[40:43], v18, s[44:47], s99 offen offset:0 sc1
  v_cvt_pk_bf16_f32 v44, v204, v205
  v_cvt_pk_bf16_f32 v45, v206, v207
  v_cvt_pk_bf16_f32 v46, v220, v221
  v_cvt_pk_bf16_f32 v47, v222, v223
  s_nop 1
  v_permlane16_swap_b32 v44, v46
  v_permlane16_swap_b32 v45, v47
  buffer_store_dwordx4 v[44:47], v18, s[44:47], s98 offen offset:0 sc1
  s_branch L_l1_fin
L_l1_epiQ:
  s_add_u32 s100, s59, 0
  s_lshl_b32 s96, s100, 12
  s_lshl_b32 s97, s69, 6
  s_add_u32 s96, s96, s97
  s_cmp_lt_u32 s100, 1024
  s_cselect_b32 s98, 0x3e8293ee, 1.0
  v_mul_f32 v96, s98, v96
  v_mul_f32 v97, s98, v97
  v_mul_f32 v98, s98, v98
  v_mul_f32 v99, s98, v99
  v_mul_f32 v112, s98, v112
  v_mul_f32 v113, s98, v113
  v_mul_f32 v114, s98, v114
  v_mul_f32 v115, s98, v115
  v_cvt_pk_bf16_f32 v24, v96, v97
  v_cvt_pk_bf16_f32 v25, v98, v99
  v_cvt_pk_bf16_f32 v26, v112, v113
  v_cvt_pk_bf16_f32 v27, v114, v115
  s_nop 1
  v_permlane16_swap_b32 v24, v26
  v_permlane16_swap_b32 v25, v27
  buffer_store_dwordx4 v[24:27], v18, s[44:47], s96 offen offset:0 sc1
  v_mul_f32 v100, s98, v100
  v_mul_f32 v101, s98, v101
  v_mul_f32 v102, s98, v102
  v_mul_f32 v103, s98, v103
  v_mul_f32 v116, s98, v116
  v_mul_f32 v117, s98, v117
  v_mul_f32 v118, s98, v118
  v_mul_f32 v119, s98, v119
  v_cvt_pk_bf16_f32 v28, v100, v101
  v_cvt_pk_bf16_f32 v29, v102, v103
  v_cvt_pk_bf16_f32 v30, v116, v117
  v_cvt_pk_bf16_f32 v31, v118, v119
  s_nop 1
  v_permlane16_swap_b32 v28, v30
  v_permlane16_swap_b32 v29, v31
  buffer_store_dwordx4 v[28:31], v18, s[44:47], s96 offen offset:1024 sc1
  v_mul_f32 v104, s98, v104
  v_mul_f32 v105, s98, v105
  v_mul_f32 v106, s98, v106
  v_mul_f32 v107, s98, v107
  v_mul_f32 v120, s98, v120
  v_mul_f32 v121, s98, v121
  v_mul_f32 v122, s98, v122
  v_mul_f32 v123, s98, v123
  v_cvt_pk_bf16_f32 v32, v104, v105
  v_cvt_pk_bf16_f32 v33, v106, v107
  v_cvt_pk_bf16_f32 v34, v120, v121
  v_cvt_pk_bf16_f32 v35, v122, v123
  s_nop 1
  v_permlane16_swap_b32 v32, v34
  v_permlane16_swap_b32 v33, v35
  buffer_store_dwordx4 v[32:35], v18, s[44:47], s96 offen offset:2048 sc1
  v_mul_f32 v108, s98, v108
  v_mul_f32 v109, s98, v109
  v_mul_f32 v110, s98, v110
  v_mul_f32 v111, s98, v111
  v_mul_f32 v124, s98, v124
  v_mul_f32 v125, s98, v125
  v_mul_f32 v126, s98, v126
  v_mul_f32 v127, s98, v127
  v_cvt_pk_bf16_f32 v36, v108, v109
  v_cvt_pk_bf16_f32 v37, v110, v111
  v_cvt_pk_bf16_f32 v38, v124, v125
  v_cvt_pk_bf16_f32 v39, v126, v127
  s_nop 1
  v_permlane16_swap_b32 v36, v38
  v_permlane16_swap_b32 v37, v39
  buffer_store_dwordx4 v[36:39], v18, s[44:47], s96 offen offset:3072 sc1
  s_add_u32 s100, s59, 32
  s_lshl_b32 s96, s100, 12
  s_lshl_b32 s97, s69, 6
  s_add_u32 s96, s96, s97
  s_cmp_lt_u32 s100, 1024
  s_cselect_b32 s98, 0x3e8293ee, 1.0
  v_mul_f32 v128, s98, v128
  v_mul_f32 v129, s98, v129
  v_mul_f32 v130, s98, v130
  v_mul_f32 v131, s98, v131
  v_mul_f32 v144, s98, v144
  v_mul_f32 v145, s98, v145
  v_mul_f32 v146, s98, v146
  v_mul_f32 v147, s98, v147
  v_cvt_pk_bf16_f32 v40, v128, v129
  v_cvt_pk_bf16_f32 v41, v130, v131
  v_cvt_pk_bf16_f32 v42, v144, v145
  v_cvt_pk_bf16_f32 v43, v146, v147
  s_nop 1
  v_permlane16_swap_b32 v40, v42
  v_permlane16_swap_b32 v41, v43
  buffer_store_dwordx4 v[40:43], v18, s[44:47], s96 offen offset:0 sc1
  v_mul_f32 v132, s98, v132
  v_mul_f32 v133, s98, v133
  v_mul_f32 v134, s98, v134
  v_mul_f32 v135, s98, v135
  v_mul_f32 v148, s98, v148
  v_mul_f32 v149, s98, v149
  v_mul_f32 v150, s98, v150
  v_mul_f32 v151, s98, v151
  v_cvt_pk_bf16_f32 v44, v132, v133
  v_cvt_pk_bf16_f32 v45, v134, v135
  v_cvt_pk_bf16_f32 v46, v148, v149
  v_cvt_pk_bf16_f32 v47, v150, v151
  s_nop 1
  v_permlane16_swap_b32 v44, v46
  v_permlane16_swap_b32 v45, v47
  buffer_store_dwordx4 v[44:47], v18, s[44:47], s96 offen offset:1024 sc1
  v_mul_f32 v136, s98, v136
  v_mul_f32 v137, s98, v137
  v_mul_f32 v138, s98, v138
  v_mul_f32 v139, s98, v139
  v_mul_f32 v152, s98, v152
  v_mul_f32 v153, s98, v153
  v_mul_f32 v154, s98, v154
  v_mul_f32 v155, s98, v155
  v_cvt_pk_bf16_f32 v24, v136, v137
  v_cvt_pk_bf16_f32 v25, v138, v139
  v_cvt_pk_bf16_f32 v26, v152, v153
  v_cvt_pk_bf16_f32 v27, v154, v155
  s_nop 1
  v_permlane16_swap_b32 v24, v26
  v_permlane16_swap_b32 v25, v27
  buffer_store_dwordx4 v[24:27], v18, s[44:47], s96 offen offset:2048 sc1
  v_mul_f32 v140, s98, v140
  v_mul_f32 v141, s98, v141
  v_mul_f32 v142, s98, v142
  v_mul_f32 v143, s98, v143
  v_mul_f32 v156, s98, v156
  v_mul_f32 v157, s98, v157
  v_mul_f32 v158, s98, v158
  v_mul_f32 v159, s98, v159
  v_cvt_pk_bf16_f32 v28, v140, v141
  v_cvt_pk_bf16_f32 v29, v142, v143
  v_cvt_pk_bf16_f32 v30, v156, v157
  v_cvt_pk_bf16_f32 v31, v158, v159
  s_nop 1
  v_permlane16_swap_b32 v28, v30
  v_permlane16_swap_b32 v29, v31
  buffer_store_dwordx4 v[28:31], v18, s[44:47], s96 offen offset:3072 sc1
  s_add_u32 s100, s59, 64
  s_lshl_b32 s96, s100, 12
  s_lshl_b32 s97, s69, 6
  s_add_u32 s96, s96, s97
  s_cmp_lt_u32 s100, 1024
  s_cselect_b32 s98, 0x3e8293ee, 1.0
  v_mul_f32 v160, s98, v160
  v_mul_f32 v161, s98, v161
  v_mul_f32 v162, s98, v162
  v_mul_f32 v163, s98, v163
  v_mul_f32 v176, s98, v176
  v_mul_f32 v177, s98, v177
  v_mul_f32 v178, s98, v178
  v_mul_f32 v179, s98, v179
  v_cvt_pk_bf16_f32 v32, v160, v161
  v_cvt_pk_bf16_f32 v33, v162, v163
  v_cvt_pk_bf16_f32 v34, v176, v177
  v_cvt_pk_bf16_f32 v35, v178, v179
  s_nop 1
  v_permlane16_swap_b32 v32, v34
  v_permlane16_swap_b32 v33, v35
  buffer_store_dwordx4 v[32:35], v18, s[44:47], s96 offen offset:0 sc1
  v_mul_f32 v164, s98, v164
  v_mul_f32 v165, s98, v165
  v_mul_f32 v166, s98, v166
  v_mul_f32 v167, s98, v167
  v_mul_f32 v180, s98, v180
  v_mul_f32 v181, s98, v181
  v_mul_f32 v182, s98, v182
  v_mul_f32 v183, s98, v183
  v_cvt_pk_bf16_f32 v36, v164, v165
  v_cvt_pk_bf16_f32 v37, v166, v167
  v_cvt_pk_bf16_f32 v38, v180, v181
  v_cvt_pk_bf16_f32 v39, v182, v183
  s_nop 1
  v_permlane16_swap_b32 v36, v38
  v_permlane16_swap_b32 v37, v39
  buffer_store_dwordx4 v[36:39], v18, s[44:47], s96 offen offset:1024 sc1
  v_mul_f32 v168, s98, v168
  v_mul_f32 v169, s98, v169
  v_mul_f32 v170, s98, v170
  v_mul_f32 v171, s98, v171
  v_mul_f32 v184, s98, v184
  v_mul_f32 v185, s98, v185
  v_mul_f32 v186, s98, v186
  v_mul_f32 v187, s98, v187
  v_cvt_pk_bf16_f32 v40, v168, v169
  v_cvt_pk_bf16_f32 v41, v170, v171
  v_cvt_pk_bf16_f32 v42, v184, v185
  v_cvt_pk_bf16_f32 v43, v186, v187
  s_nop 1
  v_permlane16_swap_b32 v40, v42
  v_permlane16_swap_b32 v41, v43
  buffer_store_dwordx4 v[40:43], v18, s[44:47], s96 offen offset:2048 sc1
  v_mul_f32 v172, s98, v172
  v_mul_f32 v173, s98, v173
  v_mul_f32 v174, s98, v174
  v_mul_f32 v175, s98, v175
  v_mul_f32 v188, s98, v188
  v_mul_f32 v189, s98, v189
  v_mul_f32 v190, s98, v190
  v_mul_f32 v191, s98, v191
  v_cvt_pk_bf16_f32 v44, v172, v173
  v_cvt_pk_bf16_f32 v45, v174, v175
  v_cvt_pk_bf16_f32 v46, v188, v189
  v_cvt_pk_bf16_f32 v47, v190, v191
  s_nop 1
  v_permlane16_swap_b32 v44, v46
  v_permlane16_swap_b32 v45, v47
  buffer_store_dwordx4 v[44:47], v18, s[44:47], s96 offen offset:3072 sc1
  s_add_u32 s100, s59, 96
  s_lshl_b32 s96, s100, 12
  s_lshl_b32 s97, s69, 6
  s_add_u32 s96, s96, s97
  s_cmp_lt_u32 s100, 1024
  s_cselect_b32 s98, 0x3e8293ee, 1.0
  v_mul_f32 v192, s98, v192
  v_mul_f32 v193, s98, v193
  v_mul_f32 v194, s98, v194
  v_mul_f32 v195, s98, v195
  v_mul_f32 v208, s98, v208
  v_mul_f32 v209, s98, v209
  v_mul_f32 v210, s98, v210
  v_mul_f32 v211, s98, v211
  v_cvt_pk_bf16_f32 v24, v192, v193
  v_cvt_pk_bf16_f32 v25, v194, v195
  v_cvt_pk_bf16_f32 v26, v208, v209
  v_cvt_pk_bf16_f32 v27, v210, v211
  s_nop 1
  v_permlane16_swap_b32 v24, v26
  v_permlane16_swap_b32 v25, v27
  buffer_store_dwordx4 v[24:27], v18, s[44:47], s96 offen offset:0 sc1
  v_mul_f32 v196, s98, v196
  v_mul_f32 v197, s98, v197
  v_mul_f32 v198, s98, v198
  v_mul_f32 v199, s98, v199
  v_mul_f32 v212, s98, v212
  v_mul_f32 v213, s98, v213
  v_mul_f32 v214, s98, v214
  v_mul_f32 v215, s98, v215
  v_cvt_pk_bf16_f32 v28, v196, v197
  v_cvt_pk_bf16_f32 v29, v198, v199
  v_cvt_pk_bf16_f32 v30, v212, v213
  v_cvt_pk_bf16_f32 v31, v214, v215
  s_nop 1
  v_permlane16_swap_b32 v28, v30
  v_permlane16_swap_b32 v29, v31
  buffer_store_dwordx4 v[28:31], v18, s[44:47], s96 offen offset:1024 sc1
  v_mul_f32 v200, s98, v200
  v_mul_f32 v201, s98, v201
  v_mul_f32 v202, s98, v202
  v_mul_f32 v203, s98, v203
  v_mul_f32 v216, s98, v216
  v_mul_f32 v217, s98, v217
  v_mul_f32 v218, s98, v218
  v_mul_f32 v219, s98, v219
  v_cvt_pk_bf16_f32 v32, v200, v201
  v_cvt_pk_bf16_f32 v33, v202, v203
  v_cvt_pk_bf16_f32 v34, v216, v217
  v_cvt_pk_bf16_f32 v35, v218, v219
  s_nop 1
  v_permlane16_swap_b32 v32, v34
  v_permlane16_swap_b32 v33, v35
  buffer_store_dwordx4 v[32:35], v18, s[44:47], s96 offen offset:2048 sc1
  v_mul_f32 v204, s98, v204
  v_mul_f32 v205, s98, v205
  v_mul_f32 v206, s98, v206
  v_mul_f32 v207, s98, v207
  v_mul_f32 v220, s98, v220
  v_mul_f32 v221, s98, v221
  v_mul_f32 v222, s98, v222
  v_mul_f32 v223, s98, v223
  v_cvt_pk_bf16_f32 v36, v204, v205
  v_cvt_pk_bf16_f32 v37, v206, v207
  v_cvt_pk_bf16_f32 v38, v220, v221
  v_cvt_pk_bf16_f32 v39, v222, v223
  s_nop 1
  v_permlane16_swap_b32 v36, v38
  v_permlane16_swap_b32 v37, v39
  buffer_store_dwordx4 v[36:39], v18, s[44:47], s96 offen offset:3072 sc1
  s_add_u32 s100, s59, 160
  s_lshl_b32 s96, s100, 12
  s_lshl_b32 s97, s69, 6
  s_add_u32 s96, s96, s97
  s_cmp_lt_u32 s100, 1024
  s_cselect_b32 s98, 0x3e8293ee, 1.0
  v_mul_f32 v224, s98, v224
  v_mul_f32 v225, s98, v225
  v_mul_f32 v226, s98, v226
  v_mul_f32 v227, s98, v227
  v_mul_f32 v240, s98, v240
  v_mul_f32 v241, s98, v241
  v_mul_f32 v242, s98, v242
  v_mul_f32 v243, s98, v243
  v_cvt_pk_bf16_f32 v40, v224, v225
  v_cvt_pk_bf16_f32 v41, v226, v227
  v_cvt_pk_bf16_f32 v42, v240, v241
  v_cvt_pk_bf16_f32 v43, v242, v243
  s_nop 1
  v_permlane16_swap_b32 v40, v42
  v_permlane16_swap_b32 v41, v43
  buffer_store_dwordx4 v[40:43], v18, s[44:47], s96 offen offset:0 sc1
  v_mul_f32 v228, s98, v228
  v_mul_f32 v229, s98, v229
  v_mul_f32 v230, s98, v230
  v_mul_f32 v231, s98, v231
  v_mul_f32 v244, s98, v244
  v_mul_f32 v245, s98, v245
  v_mul_f32 v246, s98, v246
  v_mul_f32 v247, s98, v247
  v_cvt_pk_bf16_f32 v44, v228, v229
  v_cvt_pk_bf16_f32 v45, v230, v231
  v_cvt_pk_bf16_f32 v46, v244, v245
  v_cvt_pk_bf16_f32 v47, v246, v247
  s_nop 1
  v_permlane16_swap_b32 v44, v46
  v_permlane16_swap_b32 v45, v47
  buffer_store_dwordx4 v[44:47], v18, s[44:47], s96 offen offset:1024 sc1
  v_mul_f32 v232, s98, v232
  v_mul_f32 v233, s98, v233
  v_mul_f32 v234, s98, v234
  v_mul_f32 v235, s98, v235
  v_mul_f32 v248, s98, v248
  v_mul_f32 v249, s98, v249
  v_mul_f32 v250, s98, v250
  v_mul_f32 v251, s98, v251
  v_cvt_pk_bf16_f32 v24, v232, v233
  v_cvt_pk_bf16_f32 v25, v234, v235
  v_cvt_pk_bf16_f32 v26, v248, v249
  v_cvt_pk_bf16_f32 v27, v250, v251
  s_nop 1
  v_permlane16_swap_b32 v24, v26
  v_permlane16_swap_b32 v25, v27
  buffer_store_dwordx4 v[24:27], v18, s[44:47], s96 offen offset:2048 sc1
  v_mul_f32 v236, s98, v236
  v_mul_f32 v237, s98, v237
  v_mul_f32 v238, s98, v238
  v_mul_f32 v239, s98, v239
  v_mul_f32 v252, s98, v252
  v_mul_f32 v253, s98, v253
  v_mul_f32 v254, s98, v254
  v_mul_f32 v255, s98, v255
  v_cvt_pk_bf16_f32 v28, v236, v237
  v_cvt_pk_bf16_f32 v29, v238, v239
  v_cvt_pk_bf16_f32 v30, v252, v253
  v_cvt_pk_bf16_f32 v31, v254, v255
  s_nop 1
  v_permlane16_swap_b32 v28, v30
  v_permlane16_swap_b32 v29, v31
  buffer_store_dwordx4 v[28:31], v18, s[44:47], s96 offen offset:3072 sc1
L_l1_fin:
L_l1_end:
  s_endpgm
.globl mid_kernel
.p2align 8
.type mid_kernel,@function
mid_kernel:
  s_cmp_ge_u32 s2, 768
  s_cbranch_scc1 L_mid_end
  s_add_u32 s2, s2, 256
  s_cmp_ge_u32 s2, 768
  s_cselect_b32 s3, 768, 0
  s_sub_u32 s2, s2, s3
  s_load_dwordx16 s[4:19], s[0:1], 0
  s_load_dwordx4 s[20:23], s[0:1], 64
  s_load_dwordx2 s[24:25], s[0:1], 80
  v_lshrrev_b32 v8, 6, v0
  v_and_b32 v0, 63, v0
  s_nop 0
  v_readfirstlane_b32 s52, v8
  s_nop 3
  s_lshl_b32 s53, s52, 10
  s_and_b32 s54, s52, 1
  s_lshr_b32 s55, s52, 1
  s_waitcnt lgkmcnt(0)
  s_mov_b32 s44, s24
  s_mov_b32 s45, s25
  s_mov_b32 s46, 0x10000000
  s_mov_b32 s47, 0x00020000
  s_cmp_lt_u32 s2, 256
  s_cbranch_scc1 L_mid_down
  s_sub_u32 s74, s2, 256
  s_and_b32 s72, s74, 7
  s_lshl_b32 s72, s72, 2
  s_bfe_u32 s73, s74, 0x20003
  s_add_u32 s72, s72, s73
  s_lshr_b32 s73, s74, 5
  v_and_b32 v1, 15, v0
  v_lshrrev_b32 v2, 4, v0
  v_lshlrev_b32 v3, 6, v1
  v_lshl_add_u32 v3, v2, 4, v3
  s_lshl_b32 s74, s72, 17
  s_lshl_b32 s75, s73, 13
  s_add_u32 s74, s74, s75
  s_lshl_b32 s75, s52, 11
  s_add_u32 s74, s74, s75
  buffer_load_dwordx4 v[4:7], v3, s[44:47], s74 offen offset:0
  buffer_load_dwordx4 v[8:11], v3, s[44:47], s74 offen offset:1024
  v_sub_u32 v134, 0, v2
  v_xor_b32 v134, v0, v134
  v_and_b32 v134, 3, v134
  v_and_b32 v135, 60, v0
  v_or_b32 v134, v134, v135
  v_lshlrev_b32 v128, 4, v134
  v_and_b32 v134, 1, v2
  v_lshlrev_b32 v134, 1, v134
  v_xor_b32 v134, v0, v134
  v_lshlrev_b32 v129, 4, v134
  s_lshl_b32 s75, s72, 17
  s_lshl_b32 s53, s52, 10
  s_add_u32 s75, s75, s53
  s_add_u32 s58, s75, 0x400000
  s_add_u32 s59, s75, 0x800000
  v_lshrrev_b32 v134, 2, v1
  v_sub_u32 v135, 0, v134
  v_xor_b32 v135, v135, v2
  v_and_b32 v135, 3, v135
  v_lshlrev_b32 v136, 6, v1
  v_lshl_add_u32 v130, v135, 4, v136
  v_lshl_add_u32 v135, v2, 2, v134
  v_lshlrev_b32 v135, 6, v135
  v_and_b32 v136, 3, v0
  v_lshl_add_u32 v135, v136, 3, v135
  v_add_u32 v135, 0x1000, v135
  v_and_b32 v136, 1, v2
  v_xor_b32 v137, 0, v136
  v_lshl_add_u32 v131, v137, 5, v135
  v_xor_b32 v137, 1, v136
  v_lshl_add_u32 v132, v137, 5, v135
  v_mov_b32 v92, 0x3f803f80
  v_mov_b32 v93, 0x3f803f80
  v_mov_b32 v94, 0x3f803f80
  v_mov_b32 v95, 0x3f803f80
  s_mov_b32 s79, 0x07060302
  s_lshr_b32 s78, s73, 3
  s_mov_b32 s56, s58
  s_mov_b32 s57, s59
  v_mov_b32 v68, 0
  v_mov_b32 v69, 0
  v_mov_b32 v70, 0
  v_mov_b32 v71, 0
  v_mov_b32 v72, 0
  v_mov_b32 v73, 0
  v_mov_b32 v74, 0
  v_mov_b32 v75, 0
  v_mov_b32 v76, 0
  v_mov_b32 v77, 0
  v_mov_b32 v78, 0
  v_mov_b32 v79, 0
  v_mov_b32 v80, 0
  v_mov_b32 v81, 0
  v_mov_b32 v82, 0
  v_mov_b32 v83, 0
  v_mov_b32 v12, 0
  v_mov_b32 v84, 0
  v_mov_b32 v60, 0
  v_mov_b32 v120, 0
  v_mov_b32 v13, 0
  v_mov_b32 v85, 0
  v_mov_b32 v61, 0
  v_mov_b32 v121, 0
  v_mov_b32 v14, 0
  v_mov_b32 v86, 0
  v_mov_b32 v62, 0
  v_mov_b32 v122, 0
  v_mov_b32 v15, 0
  v_mov_b32 v87, 0
  v_mov_b32 v63, 0
  v_mov_b32 v123, 0
  v_mov_b32 v16, 0
  v_mov_b32 v88, 0
  v_mov_b32 v64, 0
  v_mov_b32 v124, 0
  v_mov_b32 v17, 0
  v_mov_b32 v89, 0
  v_mov_b32 v65, 0
  v_mov_b32 v125, 0
  v_mov_b32 v18, 0
  v_mov_b32 v90, 0
  v_mov_b32 v66, 0
  v_mov_b32 v126, 0
  v_mov_b32 v19, 0
  v_mov_b32 v91, 0
  v_mov_b32 v67, 0
  v_mov_b32 v127, 0
  s_add_u32 m0, s53, 0x0
  s_add_u32 s27, s56, 0
  buffer_load_dwordx4 v128, s[44:47], s27 offen lds
  s_add_u32 m0, s53, 0x1000
  s_add_u32 s27, s57, 0
  buffer_load_dwordx4 v129, s[44:47], s27 offen lds
  s_add_u32 s56, s56, 4096
  s_add_u32 s57, s57, 4096
  s_add_u32 m0, s53, 0x2000
  s_add_u32 s27, s56, 0
  buffer_load_dwordx4 v128, s[44:47], s27 offen lds
  s_add_u32 m0, s53, 0x3000
  s_add_u32 s27, s57, 0
  buffer_load_dwordx4 v129, s[44:47], s27 offen lds
  s_add_u32 s56, s56, 4096
  s_add_u32 s57, s57, 4096
  s_add_u32 m0, s53, 0x4000
  s_add_u32 s27, s56, 0
  buffer_load_dwordx4 v128, s[44:47], s27 offen lds
  s_add_u32 m0, s53, 0x5000
  s_add_u32 s27, s57, 0
  buffer_load_dwordx4 v129, s[44:47], s27 offen lds
  s_add_u32 s56, s56, 4096
  s_add_u32 s57, s57, 4096
  s_waitcnt vmcnt(4)
  s_barrier
  ds_read_b128 v[96:99], v130 offset:0
  ds_read_b128 v[100:103], v130 offset:1024
  ds_read_b128 v[104:107], v130 offset:2048
  ds_read_b128 v[108:111], v130 offset:3072
  ds_read_b64_tr_b16 v[112:113], v131 offset:0
  ds_read_b64_tr_b16 v[114:115], v131 offset:1024
  ds_read_b64_tr_b16 v[116:117], v132 offset:0
  ds_read_b64_tr_b16 v[118:119], v132 offset:1024
  s_waitcnt lgkmcnt(0)
  v_mfma_f32_16x16x32_bf16 v[20:23], v[96:99], v[4:7], v[12:15]
  v_mfma_f32_16x16x32_bf16 v[24:27], v[96:99], v[8:11], v[16:19]
  v_mfma_f32_16x16x32_bf16 v[28:31], v[100:103], v[4:7], v[12:15]
  v_mfma_f32_16x16x32_bf16 v[32:35], v[100:103], v[8:11], v[16:19]
  s_nop 15
  v_max3_f32 v134, v20, v21, v22
  v_max3_f32 v134, v134, v23, v28
  v_max3_f32 v134, v134, v29, v30
  v_max_f32 v134, v134, v31
  v_mov_b32 v135, v134
  s_nop 1
  v_permlane16_swap_b32 v134, v135
  s_nop 1
  v_max_f32 v134, v134, v135
  v_mov_b32 v135, v134
  s_nop 1
  v_permlane32_swap_b32 v134, v135
  s_nop 1
  v_max_f32 v134, v134, v135
  v_max3_f32 v136, v24, v25, v26
  v_max3_f32 v136, v136, v27, v32
  v_max3_f32 v136, v136, v33, v34
  v_max_f32 v136, v136, v35
  v_mov_b32 v137, v136
  s_nop 1
  v_permlane16_swap_b32 v136, v137
  s_nop 1
  v_max_f32 v136, v136, v137
  v_mov_b32 v137, v136
  s_nop 1
  v_permlane32_swap_b32 v136, v137
  s_nop 1
  v_max_f32 v136, v136, v137
  v_sub_f32 v20, v20, v134
  v_sub_f32 v21, v21, v134
  v_sub_f32 v22, v22, v134
  v_sub_f32 v23, v23, v134
  v_sub_f32 v28, v28, v134
  v_sub_f32 v29, v29, v134
  v_sub_f32 v30, v30, v134
  v_sub_f32 v31, v31, v134
  v_sub_f32 v12, 0, v134
  v_sub_f32 v13, 0, v134
  v_sub_f32 v14, 0, v134
  v_sub_f32 v15, 0, v134
  v_sub_f32 v24, v24, v136
  v_sub_f32 v25, v25, v136
  v_sub_f32 v26, v26, v136
  v_sub_f32 v27, v27, v136
  v_sub_f32 v32, v32, v136
  v_sub_f32 v33, v33, v136
  v_sub_f32 v34, v34, v136
  v_sub_f32 v35, v35, v136
  v_sub_f32 v16, 0, v136
  v_sub_f32 v17, 0, v136
  v_sub_f32 v18, 0, v136
  v_sub_f32 v19, 0, v136
  s_mov_b32 s68, 8
L_at_loop:
  s_waitcnt vmcnt(2)
  s_barrier
  s_waitcnt lgkmcnt(0)
  v_mfma_f32_16x16x32_bf16 v[36:39], v[104:107], v[4:7], v[12:15]
  v_exp_f32 v20, v20
  v_mfma_f32_16x16x32_bf16 v[40:43], v[104:107], v[8:11], v[16:19]
  v_exp_f32 v21, v21
  v_exp_f32 v22, v22
  s_add_u32 m0, s53, 0x6000
  s_add_u32 s27, s56, 0
  buffer_load_dwordx4 v128, s[44:47], s27 offen lds
  s_add_u32 m0, s53, 0x7000
  v_mfma_f32_16x16x32_bf16 v[44:47], v[108:111], v[4:7], v[12:15]
  v_exp_f32 v23, v23
  v_mfma_f32_16x16x32_bf16 v[48:51], v[108:111], v[8:11], v[16:19]
  v_exp_f32 v24, v24
  v_exp_f32 v25, v25
  ds_read_b128 v[96:99], v130 offset:8192
  s_add_u32 s27, s57, 0
  buffer_load_dwordx4 v129, s[44:47], s27 offen lds
  s_add_u32 s56, s56, 4096
  s_add_u32 s57, s57, 4096
  v_mfma_f32_16x16x32_bf16 v[68:71], v[120:123], v[60:63], v[68:71]
  v_exp_f32 v26, v26
  ds_read_b128 v[100:103], v130 offset:9216
  v_mfma_f32_16x16x32_bf16 v[72:75], v[120:123], v[64:67], v[72:75]
  v_exp_f32 v27, v27
  v_exp_f32 v28, v28
  v_mfma_f32_16x16x32_bf16 v[76:79], v[124:127], v[60:63], v[76:79]
  v_exp_f32 v29, v29
  v_mfma_f32_16x16x32_bf16 v[80:83], v[124:127], v[64:67], v[80:83]
  v_exp_f32 v30, v30
  v_exp_f32 v31, v31
  v_mfma_f32_16x16x32_bf16 v[84:87], v[92:95], v[60:63], v[84:87]
  v_exp_f32 v32, v32
  ds_read_b64_tr_b16 v[120:121], v131 offset:2048
  ds_read_b64_tr_b16 v[122:123], v131 offset:3072
  v_mfma_f32_16x16x32_bf16 v[88:91], v[92:95], v[64:67], v[88:91]
  v_exp_f32 v33, v33
  v_exp_f32 v34, v34
  ds_read_b64_tr_b16 v[124:125], v132 offset:2048
  ds_read_b64_tr_b16 v[126:127], v132 offset:3072
  v_exp_f32 v35, v35
  v_cvt_pk_bf16_f32 v52, v20, v21
  v_cvt_pk_bf16_f32 v53, v22, v23
  v_cvt_pk_bf16_f32 v54, v28, v29
  v_cvt_pk_bf16_f32 v55, v30, v31
  v_cvt_pk_bf16_f32 v56, v24, v25
  v_cvt_pk_bf16_f32 v57, v26, v27
  v_cvt_pk_bf16_f32 v58, v32, v33
  v_cvt_pk_bf16_f32 v59, v34, v35
  s_waitcnt lgkmcnt(0)
  v_mfma_f32_16x16x32_bf16 v[20:23], v[96:99], v[4:7], v[12:15]
  v_exp_f32 v36, v36
  v_mfma_f32_16x16x32_bf16 v[24:27], v[96:99], v[8:11], v[16:19]
  v_exp_f32 v37, v37
  v_exp_f32 v38, v38
  v_mfma_f32_16x16x32_bf16 v[28:31], v[100:103], v[4:7], v[12:15]
  v_exp_f32 v39, v39
  v_mfma_f32_16x16x32_bf16 v[32:35], v[100:103], v[8:11], v[16:19]
  v_exp_f32 v40, v40
  v_exp_f32 v41, v41
  ds_read_b128 v[104:107], v130 offset:10240
  v_mfma_f32_16x16x32_bf16 v[68:71], v[112:115], v[52:55], v[68:71]
  v_exp_f32 v42, v42
  ds_read_b128 v[108:111], v130 offset:11264
  v_mfma_f32_16x16x32_bf16 v[72:75], v[112:115], v[56:59], v[72:75]
  v_exp_f32 v43, v43
  v_exp_f32 v44, v44
  v_mfma_f32_16x16x32_bf16 v[76:79], v[116:119], v[52:55], v[76:79]
  v_exp_f32 v45, v45
  v_mfma_f32_16x16x32_bf16 v[80:83], v[116:119], v[56:59], v[80:83]
  v_exp_f32 v46, v46
  v_exp_f32 v47, v47
  v_mfma_f32_16x16x32_bf16 v[84:87], v[92:95], v[52:55], v[84:87]
  v_exp_f32 v48, v48
  ds_read_b64_tr_b16 v[112:113], v131 offset:8192
  ds_read_b64_tr_b16 v[114:115], v131 offset:9216
  v_mfma_f32_16x16x32_bf16 v[88:91], v[92:95], v[56:59], v[88:91]
  v_exp_f32 v49, v49
  v_exp_f32 v50, v50
  ds_read_b64_tr_b16 v[116:117], v132 offset:8192
  ds_read_b64_tr_b16 v[118:119], v132 offset:9216
  v_exp_f32 v51, v51
  v_cvt_pk_bf16_f32 v60, v36, v37
  v_cvt_pk_bf16_f32 v61, v38, v39
  v_cvt_pk_bf16_f32 v62, v44, v45
  v_cvt_pk_bf16_f32 v63, v46, v47
  v_cvt_pk_bf16_f32 v64, v40, v41
  v_cvt_pk_bf16_f32 v65, v42, v43
  v_cvt_pk_bf16_f32 v66, v48, v49
  v_cvt_pk_bf16_f32 v67, v50, v51
  s_waitcnt vmcnt(2)
  s_barrier
  s_waitcnt lgkmcnt(0)
  v_mfma_f32_16x16x32_bf16 v[36:39], v[104:107], v[4:7], v[12:15]
  v_exp_f32 v20, v20
  v_mfma_f32_16x16x32_bf16 v[40:43], v[104:107], v[8:11], v[16:19]
  v_exp_f32 v21, v21
  v_exp_f32 v22, v22
  s_add_u32 m0, s53, 0x0
  s_add_u32 s27, s56, 0
  buffer_load_dwordx4 v128, s[44:47], s27 offen lds
  s_add_u32 m0, s53, 0x1000
  v_mfma_f32_16x16x32_bf16 v[44:47], v[108:111], v[4:7], v[12:15]
  v_exp_f32 v23, v23
  v_mfma_f32_16x16x32_bf16 v[48:51], v[108:111], v[8:11], v[16:19]
  v_exp_f32 v24, v24
  v_exp_f32 v25, v25
  ds_read_b128 v[96:99], v130 offset:16384
  s_add_u32 s27, s57, 0
  buffer_load_dwordx4 v129, s[44:47], s27 offen lds
  s_add_u32 s56, s56, 4096
  s_add_u32 s57, s57, 4096
  v_mfma_f32_16x16x32_bf16 v[68:71], v[120:123], v[60:63], v[68:71]
  v_exp_f32 v26, v26
  ds_read_b128 v[100:103], v130 offset:17408
  v_mfma_f32_16x16x32_bf16 v[72:75], v[120:123], v[64:67], v[72:75]
  v_exp_f32 v27, v27
  v_exp_f32 v28, v28
  v_mfma_f32_16x16x32_bf16 v[76:79], v[124:127], v[60:63], v[76:79]
  v_exp_f32 v29, v29
  v_mfma_f32_16x16x32_bf16 v[80:83], v[124:127], v[64:67], v[80:83]
  v_exp_f32 v30, v30
  v_exp_f32 v31, v31
  v_mfma_f32_16x16x32_bf16 v[84:87], v[92:95], v[60:63], v[84:87]
  v_exp_f32 v32, v32
  ds_read_b64_tr_b16 v[120:121], v131 offset:10240
  ds_read_b64_tr_b16 v[122:123], v131 offset:11264
  v_mfma_f32_16x16x32_bf16 v[88:91], v[92:95], v[64:67], v[88:91]
  v_exp_f32 v33, v33
  v_exp_f32 v34, v34
  ds_read_b64_tr_b16 v[124:125], v132 offset:10240
  ds_read_b64_tr_b16 v[126:127], v132 offset:11264
  v_exp_f32 v35, v35
  v_cvt_pk_bf16_f32 v52, v20, v21
  v_cvt_pk_bf16_f32 v53, v22, v23
  v_cvt_pk_bf16_f32 v54, v28, v29
  v_cvt_pk_bf16_f32 v55, v30, v31
  v_cvt_pk_bf16_f32 v56, v24, v25
  v_cvt_pk_bf16_f32 v57, v26, v27
  v_cvt_pk_bf16_f32 v58, v32, v33
  v_cvt_pk_bf16_f32 v59, v34, v35
  s_waitcnt lgkmcnt(0)
  v_mfma_f32_16x16x32_bf16 v[20:23], v[96:99], v[4:7], v[12:15]
  v_exp_f32 v36, v36
  v_mfma_f32_16x16x32_bf16 v[24:27], v[96:99], v[8:11], v[16:19]
  v_exp_f32 v37, v37
  v_exp_f32 v38, v38
  v_mfma_f32_16x16x32_bf16 v[28:31], v[100:103], v[4:7], v[12:15]
  v_exp_f32 v39, v39
  v_mfma_f32_16x16x32_bf16 v[32:35], v[100:103], v[8:11], v[16:19]
  v_exp_f32 v40, v40
  v_exp_f32 v41, v41
  ds_read_b128 v[104:107], v130 offset:18432
  v_mfma_f32_16x16x32_bf16 v[68:71], v[112:115], v[52:55], v[68:71]
  v_exp_f32 v42, v42
  ds_read_b128 v[108:111], v130 offset:19456
  v_mfma_f32_16x16x32_bf16 v[72:75], v[112:115], v[56:59], v[72:75]
  v_exp_f32 v43, v43
  v_exp_f32 v44, v44
  v_mfma_f32_16x16x32_bf16 v[76:79], v[116:119], v[52:55], v[76:79]
  v_exp_f32 v45, v45
  v_mfma_f32_16x16x32_bf16 v[80:83], v[116:119], v[56:59], v[80:83]
  v_exp_f32 v46, v46
  v_exp_f32 v47, v47
  v_mfma_f32_16x16x32_bf16 v[84:87], v[92:95], v[52:55], v[84:87]
  v_exp_f32 v48, v48
  ds_read_b64_tr_b16 v[112:113], v131 offset:16384
  ds_read_b64_tr_b16 v[114:115], v131 offset:17408
  v_mfma_f32_16x16x32_bf16 v[88:91], v[92:95], v[56:59], v[88:91]
  v_exp_f32 v49, v49
  v_exp_f32 v50, v50
  ds_read_b64_tr_b16 v[116:117], v132 offset:16384
  ds_read_b64_tr_b16 v[118:119], v132 offset:17408
  v_exp_f32 v51, v51
  v_cvt_pk_bf16_f32 v60, v36, v37
  v_cvt_pk_bf16_f32 v61, v38, v39
  v_cvt_pk_bf16_f32 v62, v44, v45
  v_cvt_pk_bf16_f32 v63, v46, v47
  v_cvt_pk_bf16_f32 v64, v40, v41
  v_cvt_pk_bf16_f32 v65, v42, v43
  v_cvt_pk_bf16_f32 v66, v48, v49
  v_cvt_pk_bf16_f32 v67, v50, v51
  s_waitcnt vmcnt(2)
  s_barrier
  s_waitcnt lgkmcnt(0)
  v_mfma_f32_16x16x32_bf16 v[36:39], v[104:107], v[4:7], v[12:15]
  v_exp_f32 v20, v20
  v_mfma_f32_16x16x32_bf16 v[40:43], v[104:107], v[8:11], v[16:19]
  v_exp_f32 v21, v21
  v_exp_f32 v22, v22
  s_add_u32 m0, s53, 0x2000
  s_add_u32 s27, s56, 0
  buffer_load_dwordx4 v128, s[44:47], s27 offen lds
  s_add_u32 m0, s53, 0x3000
  v_mfma_f32_16x16x32_bf16 v[44:47], v[108:111], v[4:7], v[12:15]
  v_exp_f32 v23, v23
  v_mfma_f32_16x16x32_bf16 v[48:51], v[108:111], v[8:11], v[16:19]
  v_exp_f32 v24, v24
  v_exp_f32 v25, v25
  ds_read_b128 v[96:99], v130 offset:24576
  s_add_u32 s27, s57, 0
  buffer_load_dwordx4 v129, s[44:47], s27 offen lds
  s_add_u32 s56, s56, 4096
  s_add_u32 s57, s57, 4096
  v_mfma_f32_16x16x32_bf16 v[68:71], v[120:123], v[60:63], v[68:71]
  v_exp_f32 v26, v26
  ds_read_b128 v[100:103], v130 offset:25600
  v_mfma_f32_16x16x32_bf16 v[72:75], v[120:123], v[64:67], v[72:75]
  v_exp_f32 v27, v27
  v_exp_f32 v28, v28
  v_mfma_f32_16x16x32_bf16 v[76:79], v[124:127], v[60:63], v[76:79]
  v_exp_f32 v29, v29
  v_mfma_f32_16x16x32_bf16 v[80:83], v[124:127], v[64:67], v[80:83]
  v_exp_f32 v30, v30
  v_exp_f32 v31, v31
  v_mfma_f32_16x16x32_bf16 v[84:87], v[92:95], v[60:63], v[84:87]
  v_exp_f32 v32, v32
  ds_read_b64_tr_b16 v[120:121], v131 offset:18432
  ds_read_b64_tr_b16 v[122:123], v131 offset:19456
  v_mfma_f32_16x16x32_bf16 v[88:91], v[92:95], v[64:67], v[88:91]
  v_exp_f32 v33, v33
  v_exp_f32 v34, v34
  ds_read_b64_tr_b16 v[124:125], v132 offset:18432
  ds_read_b64_tr_b16 v[126:127], v132 offset:19456
  v_exp_f32 v35, v35
  v_cvt_pk_bf16_f32 v52, v20, v21
  v_cvt_pk_bf16_f32 v53, v22, v23
  v_cvt_pk_bf16_f32 v54, v28, v29
  v_cvt_pk_bf16_f32 v55, v30, v31
  v_cvt_pk_bf16_f32 v56, v24, v25
  v_cvt_pk_bf16_f32 v57, v26, v27
  v_cvt_pk_bf16_f32 v58, v32, v33
  v_cvt_pk_bf16_f32 v59, v34, v35
  s_waitcnt lgkmcnt(0)
  v_mfma_f32_16x16x32_bf16 v[20:23], v[96:99], v[4:7], v[12:15]
  v_exp_f32 v36, v36
  v_mfma_f32_16x16x32_bf16 v[24:27], v[96:99], v[8:11], v[16:19]
  v_exp_f32 v37, v37
  v_exp_f32 v38, v38
  v_mfma_f32_16x16x32_bf16 v[28:31], v[100:103], v[4:7], v[12:15]
  v_exp_f32 v39, v39
  v_mfma_f32_16x16x32_bf16 v[32:35], v[100:103], v[8:11], v[16:19]
  v_exp_f32 v40, v40
  v_exp_f32 v41, v41
  ds_read_b128 v[104:107], v130 offset:26624
  v_mfma_f32_16x16x32_bf16 v[68:71], v[112:115], v[52:55], v[68:71]
  v_exp_f32 v42, v42
  ds_read_b128 v[108:111], v130 offset:27648
  v_mfma_f32_16x16x32_bf16 v[72:75], v[112:115], v[56:59], v[72:75]
  v_exp_f32 v43, v43
  v_exp_f32 v44, v44
  v_mfma_f32_16x16x32_bf16 v[76:79], v[116:119], v[52:55], v[76:79]
  v_exp_f32 v45, v45
  v_mfma_f32_16x16x32_bf16 v[80:83], v[116:119], v[56:59], v[80:83]
  v_exp_f32 v46, v46
  v_exp_f32 v47, v47
  v_mfma_f32_16x16x32_bf16 v[84:87], v[92:95], v[52:55], v[84:87]
  v_exp_f32 v48, v48
  ds_read_b64_tr_b16 v[112:113], v131 offset:24576
  ds_read_b64_tr_b16 v[114:115], v131 offset:25600
  v_mfma_f32_16x16x32_bf16 v[88:91], v[92:95], v[56:59], v[88:91]
  v_exp_f32 v49, v49
  v_exp_f32 v50, v50
  ds_read_b64_tr_b16 v[116:117], v132 offset:24576
  ds_read_b64_tr_b16 v[118:119], v132 offset:25600
  v_exp_f32 v51, v51
  v_cvt_pk_bf16_f32 v60, v36, v37
  v_cvt_pk_bf16_f32 v61, v38, v39
  v_cvt_pk_bf16_f32 v62, v44, v45
  v_cvt_pk_bf16_f32 v63, v46, v47
  v_cvt_pk_bf16_f32 v64, v40, v41
  v_cvt_pk_bf16_f32 v65, v42, v43
  v_cvt_pk_bf16_f32 v66, v48, v49
  v_cvt_pk_bf16_f32 v67, v50, v51
  s_waitcnt vmcnt(2)
  s_barrier
  s_waitcnt lgkmcnt(0)
  v_mfma_f32_16x16x32_bf16 v[36:39], v[104:107], v[4:7], v[12:15]
  v_exp_f32 v20, v20
  v_mfma_f32_16x16x32_bf16 v[40:43], v[104:107], v[8:11], v[16:19]
  v_exp_f32 v21, v21
  v_exp_f32 v22, v22
  s_add_u32 m0, s53, 0x4000
  s_add_u32 s27, s56, 0
  buffer_load_dwordx4 v128, s[44:47], s27 offen lds
  s_add_u32 m0, s53, 0x5000
  v_mfma_f32_16x16x32_bf16 v[44:47], v[108:111], v[4:7], v[12:15]
  v_exp_f32 v23, v23
  v_mfma_f32_16x16x32_bf16 v[48:51], v[108:111], v[8:11], v[16:19]
  v_exp_f32 v24, v24
  v_exp_f32 v25, v25
  ds_read_b128 v[96:99], v130 offset:0
  s_add_u32 s27, s57, 0
  buffer_load_dwordx4 v129, s[44:47], s27 offen lds
  s_add_u32 s56, s56, 4096
  s_add_u32 s57, s57, 4096
  v_mfma_f32_16x16x32_bf16 v[68:71], v[120:123], v[60:63], v[68:71]
  v_exp_f32 v26, v26
  ds_read_b128 v[100:103], v130 offset:1024
  v_mfma_f32_16x16x32_bf16 v[72:75], v[120:123], v[64:67], v[72:75]
  v_exp_f32 v27, v27
  v_exp_f32 v28, v28
  v_mfma_f32_16x16x32_bf16 v[76:79], v[124:127], v[60:63], v[76:79]
  v_exp_f32 v29, v29
  v_mfma_f32_16x16x32_bf16 v[80:83], v[124:127], v[64:67], v[80:83]
  v_exp_f32 v30, v30
  v_exp_f32 v31, v31
  v_mfma_f32_16x16x32_bf16 v[84:87], v[92:95], v[60:63], v[84:87]
  v_exp_f32 v32, v32
  ds_read_b64_tr_b16 v[120:121], v131 offset:26624
  ds_read_b64_tr_b16 v[122:123], v131 offset:27648
  v_mfma_f32_16x16x32_bf16 v[88:91], v[92:95], v[64:67], v[88:91]
  v_exp_f32 v33, v33
  v_exp_f32 v34, v34
  ds_read_b64_tr_b16 v[124:125], v132 offset:26624
  ds_read_b64_tr_b16 v[126:127], v132 offset:27648
  v_exp_f32 v35, v35
  v_cvt_pk_bf16_f32 v52, v20, v21
  v_cvt_pk_bf16_f32 v53, v22, v23
  v_cvt_pk_bf16_f32 v54, v28, v29
  v_cvt_pk_bf16_f32 v55, v30, v31
  v_cvt_pk_bf16_f32 v56, v24, v25
  v_cvt_pk_bf16_f32 v57, v26, v27
  v_cvt_pk_bf16_f32 v58, v32, v33
  v_cvt_pk_bf16_f32 v59, v34, v35
  s_waitcnt lgkmcnt(0)
  v_mfma_f32_16x16x32_bf16 v[20:23], v[96:99], v[4:7], v[12:15]
  v_exp_f32 v36, v36
  v_mfma_f32_16x16x32_bf16 v[24:27], v[96:99], v[8:11], v[16:19]
  v_exp_f32 v37, v37
  v_exp_f32 v38, v38
  v_mfma_f32_16x16x32_bf16 v[28:31], v[100:103], v[4:7], v[12:15]
  v_exp_f32 v39, v39
  v_mfma_f32_16x16x32_bf16 v[32:35], v[100:103], v[8:11], v[16:19]
  v_exp_f32 v40, v40
  v_exp_f32 v41, v41
  ds_read_b128 v[104:107], v130 offset:2048
  v_mfma_f32_16x16x32_bf16 v[68:71], v[112:115], v[52:55], v[68:71]
  v_exp_f32 v42, v42
  ds_read_b128 v[108:111], v130 offset:3072
  v_mfma_f32_16x16x32_bf16 v[72:75], v[112:115], v[56:59], v[72:75]
  v_exp_f32 v43, v43
  v_exp_f32 v44, v44
  v_mfma_f32_16x16x32_bf16 v[76:79], v[116:119], v[52:55], v[76:79]
  v_exp_f32 v45, v45
  v_mfma_f32_16x16x32_bf16 v[80:83], v[116:119], v[56:59], v[80:83]
  v_exp_f32 v46, v46
  v_exp_f32 v47, v47
  v_mfma_f32_16x16x32_bf16 v[84:87], v[92:95], v[52:55], v[84:87]
  v_exp_f32 v48, v48
  ds_read_b64_tr_b16 v[112:113], v131 offset:0
  ds_read_b64_tr_b16 v[114:115], v131 offset:1024
  v_mfma_f32_16x16x32_bf16 v[88:91], v[92:95], v[56:59], v[88:91]
  v_exp_f32 v49, v49
  v_exp_f32 v50, v50
  ds_read_b64_tr_b16 v[116:117], v132 offset:0
  ds_read_b64_tr_b16 v[118:119], v132 offset:1024
  v_exp_f32 v51, v51
  v_cvt_pk_bf16_f32 v60, v36, v37
  v_cvt_pk_bf16_f32 v61, v38, v39
  v_cvt_pk_bf16_f32 v62, v44, v45
  v_cvt_pk_bf16_f32 v63, v46, v47
  v_cvt_pk_bf16_f32 v64, v40, v41
  v_cvt_pk_bf16_f32 v65, v42, v43
  v_cvt_pk_bf16_f32 v66, v48, v49
  v_cvt_pk_bf16_f32 v67, v50, v51
  s_sub_u32 s68, s68, 1
  s_cmp_lg_u32 s68, 0
  s_cbranch_scc1 L_at_loop
  s_nop 1
  v_mfma_f32_16x16x32_bf16 v[68:71], v[120:123], v[60:63], v[68:71]
  v_mfma_f32_16x16x32_bf16 v[72:75], v[120:123], v[64:67], v[72:75]
  v_mfma_f32_16x16x32_bf16 v[76:79], v[124:127], v[60:63], v[76:79]
  v_mfma_f32_16x16x32_bf16 v[80:83], v[124:127], v[64:67], v[80:83]
  v_mfma_f32_16x16x32_bf16 v[84:87], v[92:95], v[60:63], v[84:87]
  v_mfma_f32_16x16x32_bf16 v[88:91], v[92:95], v[64:67], v[88:91]
  s_waitcnt vmcnt(0) lgkmcnt(0)
  s_nop 15
  v_mov_b32 v136, 0x5d800000
  v_max_f32 v137, v84, v88
  v_cmp_lt_f32 vcc, v84, v136
  v_cmp_lt_f32 s[76:77], v88, v136
  s_nop 1
  s_and_b64 vcc, vcc, s[76:77]
  s_cmp_eq_u64 vcc, exec
  s_cselect_b32 s76, 0, 1
  s_barrier
  v_mov_b32 v136, 0x8000
  v_mov_b32 v137, s76
  s_lshl_b32 s77, s52, 2
  v_add_u32 v138, s77, v136
  ds_write_b32 v138, v137
  s_waitcnt lgkmcnt(0)
  s_barrier
  ds_read_b128 v[138:141], v136
  s_waitcnt lgkmcnt(0)
  v_or_b32 v138, v138, v139
  v_or_b32 v140, v140, v141
  v_or_b32 v138, v138, v140
  s_nop 0
  v_readfirstlane_b32 s76, v138
  s_nop 3
  s_cmp_lg_u32 s76, 0
  s_cbranch_scc1 L_at_slow
L_at_fin:
  v_rcp_f32 v134, v84
  v_rcp_f32 v135, v88
  s_nop 0
  v_mul_f32 v68, v68, v134
  v_mul_f32 v69, v69, v134
  v_mul_f32 v70, v70, v134
  v_mul_f32 v71, v71, v134
  v_mul_f32 v72, v72, v135
  v_mul_f32 v73, v73, v135
  v_mul_f32 v74, v74, v135
  v_mul_f32 v75, v75, v135
  v_mul_f32 v76, v76, v134
  v_mul_f32 v77, v77, v134
  v_mul_f32 v78, v78, v134
  v_mul_f32 v79, v79, v134
  v_mul_f32 v80, v80, v135
  v_mul_f32 v81, v81, v135
  v_mul_f32 v82, v82, v135
  v_mul_f32 v83, v83, v135
  v_cvt_pk_bf16_f32 v52, v68, v69
  v_cvt_pk_bf16_f32 v53, v70, v71
  v_cvt_pk_bf16_f32 v54, v76, v77
  v_cvt_pk_bf16_f32 v55, v78, v79
  v_cvt_pk_bf16_f32 v56, v72, v73
  v_cvt_pk_bf16_f32 v57, v74, v75
  v_cvt_pk_bf16_f32 v58, v80, v81
  v_cvt_pk_bf16_f32 v59, v82, v83
  v_and_b32 v136, 1, v2
  v_lshlrev_b32 v136, 5, v136
  v_lshrrev_b32 v137, 1, v2
  v_lshl_add_u32 v136, v137, 4, v136
  v_lshl_add_u32 v136, v1, 6, v136
  s_lshl_b32 s74, s73, 13
  s_lshl_b32 s75, s52, 11
  s_add_u32 s74, s74, s75
  s_lshl_b32 s75, s72, 17
  s_add_u32 s74, s74, s75
  s_add_u32 s74, s74, 0x1c00000
  s_add_u32 s75, s74, 0x400
  v_permlane16_swap_b32 v52, v54
  v_permlane16_swap_b32 v53, v55
  buffer_store_dwordx4 v[52:55], v136, s[44:47], s74 offen offset:0 sc1
  v_permlane16_swap_b32 v56, v58
  v_permlane16_swap_b32 v57, v59
  buffer_store_dwordx4 v[56:59], v136, s[44:47], s75 offen offset:0 sc1
  s_endpgm
L_at_slow:
  s_barrier
  s_mov_b32 s56, s58
  s_mov_b32 s57, s59
  v_mov_b32 v68, 0
  v_mov_b32 v69, 0
  v_mov_b32 v70, 0
  v_mov_b32 v71, 0
  v_mov_b32 v72, 0
  v_mov_b32 v73, 0
  v_mov_b32 v74, 0
  v_mov_b32 v75, 0
  v_mov_b32 v76, 0
  v_mov_b32 v77, 0
  v_mov_b32 v78, 0
  v_mov_b32 v79, 0
  v_mov_b32 v80, 0
  v_mov_b32 v81, 0
  v_mov_b32 v82, 0
  v_mov_b32 v83, 0
  v_mov_b32 v36, 0
  v_mov_b32 v37, 0
  v_mov_b32 v38, 0
  v_mov_b32 v39, 0
  v_mov_b32 v12, 0xff7fffff
  v_mov_b32 v14, 0
  v_mov_b32 v13, 0xff7fffff
  v_mov_b32 v15, 0
  s_mov_b32 s68, 32
L_at_sloop:
  s_add_u32 m0, s53, 0x0
  s_add_u32 s27, s56, 0
  buffer_load_dwordx4 v128, s[44:47], s27 offen lds
  s_add_u32 m0, s53, 0x1000
  s_add_u32 s27, s57, 0
  buffer_load_dwordx4 v129, s[44:47], s27 offen lds
  s_add_u32 s56, s56, 4096
  s_add_u32 s57, s57, 4096
  s_waitcnt vmcnt(0)
  s_barrier
  ds_read_b128 v[96:99], v130 offset:0
  ds_read_b128 v[100:103], v130 offset:1024
  ds_read_b64_tr_b16 v[112:113], v131 offset:0
  ds_read_b64_tr_b16 v[114:115], v131 offset:1024
  ds_read_b64_tr_b16 v[116:117], v132 offset:0
  ds_read_b64_tr_b16 v[118:119], v132 offset:1024
  s_waitcnt lgkmcnt(0)
  v_mfma_f32_16x16x32_bf16 v[20:23], v[96:99], v[4:7], v[36:39]
  v_mfma_f32_16x16x32_bf16 v[24:27], v[96:99], v[8:11], v[36:39]
  v_mfma_f32_16x16x32_bf16 v[28:31], v[100:103], v[4:7], v[36:39]
  v_mfma_f32_16x16x32_bf16 v[32:35], v[100:103], v[8:11], v[36:39]
  s_nop 15
  v_max3_f32 v134, v20, v21, v22
  v_max3_f32 v134, v134, v23, v28
  v_max3_f32 v134, v134, v29, v30
  v_max3_f32 v134, v134, v31, v12
  v_mov_b32 v135, v134
  s_nop 1
  v_permlane16_swap_b32 v134, v135
  s_nop 1
  v_max_f32 v134, v134, v135
  v_mov_b32 v135, v134
  s_nop 1
  v_permlane32_swap_b32 v134, v135
  s_nop 1
  v_max_f32 v134, v134, v135
  v_max3_f32 v136, v24, v25, v26
  v_max3_f32 v136, v136, v27, v32
  v_max3_f32 v136, v136, v33, v34
  v_max3_f32 v136, v136, v35, v13
  v_mov_b32 v137, v136
  s_nop 1
  v_permlane16_swap_b32 v136, v137
  s_nop 1
  v_max_f32 v136, v136, v137
  v_mov_b32 v137, v136
  s_nop 1
  v_permlane32_swap_b32 v136, v137
  s_nop 1
  v_max_f32 v136, v136, v137
  v_sub_f32 v16, v12, v134
  v_exp_f32 v16, v16
  v_mov_b32 v12, v134
  v_sub_f32 v17, v13, v136
  v_exp_f32 v17, v17
  v_mov_b32 v13, v136
  v_sub_f32 v20, v20, v12
  v_sub_f32 v21, v21, v12
  v_sub_f32 v22, v22, v12
  v_sub_f32 v23, v23, v12
  v_sub_f32 v28, v28, v12
  v_sub_f32 v29, v29, v12
  v_sub_f32 v30, v30, v12
  v_sub_f32 v31, v31, v12
  v_sub_f32 v24, v24, v13
  v_sub_f32 v25, v25, v13
  v_sub_f32 v26, v26, v13
  v_sub_f32 v27, v27, v13
  v_sub_f32 v32, v32, v13
  v_sub_f32 v33, v33, v13
  v_sub_f32 v34, v34, v13
  v_sub_f32 v35, v35, v13
  v_exp_f32 v20, v20
  v_exp_f32 v21, v21
  v_exp_f32 v22, v22
  v_exp_f32 v23, v23
  v_exp_f32 v24, v24
  v_exp_f32 v25, v25
  v_exp_f32 v26, v26
  v_exp_f32 v27, v27
  v_exp_f32 v28, v28
  v_exp_f32 v29, v29
  v_exp_f32 v30, v30
  v_exp_f32 v31, v31
  v_exp_f32 v32, v32
  v_exp_f32 v33, v33
  v_exp_f32 v34, v34
  v_exp_f32 v35, v35
  v_mul_f32 v14, v14, v16
  v_mul_f32 v68, v68, v16
  v_mul_f32 v69, v69, v16
  v_mul_f32 v70, v70, v16
  v_mul_f32 v71, v71, v16
  v_mul_f32 v76, v76, v16
  v_mul_f32 v77, v77, v16
  v_mul_f32 v78, v78, v16
  v_mul_f32 v79, v79, v16
  v_add_f32 v14, v14, v20
  v_add_f32 v14, v14, v21
  v_add_f32 v14, v14, v22
  v_add_f32 v14, v14, v23
  v_add_f32 v14, v14, v28
  v_add_f32 v14, v14, v29
  v_add_f32 v14, v14, v30
  v_add_f32 v14, v14, v31
  v_mul_f32 v15, v15, v17
  v_mul_f32 v72, v72, v17
  v_mul_f32 v73, v73, v17
  v_mul_f32 v74, v74, v17
  v_mul_f32 v75, v75, v17
  v_mul_f32 v80, v80, v17
  v_mul_f32 v81, v81, v17
  v_mul_f32 v82, v82, v17
  v_mul_f32 v83, v83, v17
  v_add_f32 v15, v15, v24
  v_add_f32 v15, v15, v25
  v_add_f32 v15, v15, v26
  v_add_f32 v15, v15, v27
  v_add_f32 v15, v15, v32
  v_add_f32 v15, v15, v33
  v_add_f32 v15, v15, v34
  v_add_f32 v15, v15, v35
  v_cvt_pk_bf16_f32 v52, v20, v21
  v_cvt_pk_bf16_f32 v53, v22, v23
  v_cvt_pk_bf16_f32 v54, v28, v29
  v_cvt_pk_bf16_f32 v55, v30, v31
  v_cvt_pk_bf16_f32 v56, v24, v25
  v_cvt_pk_bf16_f32 v57, v26, v27
  v_cvt_pk_bf16_f32 v58, v32, v33
  v_cvt_pk_bf16_f32 v59, v34, v35
  s_nop 1
  v_mfma_f32_16x16x32_bf16 v[68:71], v[112:115], v[52:55], v[68:71]
  v_mfma_f32_16x16x32_bf16 v[72:75], v[112:115], v[56:59], v[72:75]
  v_mfma_f32_16x16x32_bf16 v[76:79], v[116:119], v[52:55], v[76:79]
  v_mfma_f32_16x16x32_bf16 v[80:83], v[116:119], v[56:59], v[80:83]
  s_nop 15
  ds_read_b128 v[96:99], v130 offset:2048
  ds_read_b128 v[100:103], v130 offset:3072
  ds_read_b64_tr_b16 v[112:113], v131 offset:2048
  ds_read_b64_tr_b16 v[114:115], v131 offset:3072
  ds_read_b64_tr_b16 v[116:117], v132 offset:2048
  ds_read_b64_tr_b16 v[118:119], v132 offset:3072
  s_waitcnt lgkmcnt(0)
  v_mfma_f32_16x16x32_bf16 v[20:23], v[96:99], v[4:7], v[36:39]
  v_mfma_f32_16x16x32_bf16 v[24:27], v[96:99], v[8:11], v[36:39]
  v_mfma_f32_16x16x32_bf16 v[28:31], v[100:103], v[4:7], v[36:39]
  v_mfma_f32_16x16x32_bf16 v[32:35], v[100:103], v[8:11], v[36:39]
  s_nop 15
  v_max3_f32 v134, v20, v21, v22
  v_max3_f32 v134, v134, v23, v28
  v_max3_f32 v134, v134, v29, v30
  v_max3_f32 v134, v134, v31, v12
  v_mov_b32 v135, v134
  s_nop 1
  v_permlane16_swap_b32 v134, v135
  s_nop 1
  v_max_f32 v134, v134, v135
  v_mov_b32 v135, v134
  s_nop 1
  v_permlane32_swap_b32 v134, v135
  s_nop 1
  v_max_f32 v134, v134, v135
  v_max3_f32 v136, v24, v25, v26
  v_max3_f32 v136, v136, v27, v32
  v_max3_f32 v136, v136, v33, v34
  v_max3_f32 v136, v136, v35, v13
  v_mov_b32 v137, v136
  s_nop 1
  v_permlane16_swap_b32 v136, v137
  s_nop 1
  v_max_f32 v136, v136, v137
  v_mov_b32 v137, v136
  s_nop 1
  v_permlane32_swap_b32 v136, v137
  s_nop 1
  v_max_f32 v136, v136, v137
  v_sub_f32 v16, v12, v134
  v_exp_f32 v16, v16
  v_mov_b32 v12, v134
  v_sub_f32 v17, v13, v136
  v_exp_f32 v17, v17
  v_mov_b32 v13, v136
  v_sub_f32 v20, v20, v12
  v_sub_f32 v21, v21, v12
  v_sub_f32 v22, v22, v12
  v_sub_f32 v23, v23, v12
  v_sub_f32 v28, v28, v12
  v_sub_f32 v29, v29, v12
  v_sub_f32 v30, v30, v12
  v_sub_f32 v31, v31, v12
  v_sub_f32 v24, v24, v13
  v_sub_f32 v25, v25, v13
  v_sub_f32 v26, v26, v13
  v_sub_f32 v27, v27, v13
  v_sub_f32 v32, v32, v13
  v_sub_f32 v33, v33, v13
  v_sub_f32 v34, v34, v13
  v_sub_f32 v35, v35, v13
  v_exp_f32 v20, v20
  v_exp_f32 v21, v21
  v_exp_f32 v22, v22
  v_exp_f32 v23, v23
  v_exp_f32 v24, v24
  v_exp_f32 v25, v25
  v_exp_f32 v26, v26
  v_exp_f32 v27, v27
  v_exp_f32 v28, v28
  v_exp_f32 v29, v29
  v_exp_f32 v30, v30
  v_exp_f32 v31, v31
  v_exp_f32 v32, v32
  v_exp_f32 v33, v33
  v_exp_f32 v34, v34
  v_exp_f32 v35, v35
  v_mul_f32 v14, v14, v16
  v_mul_f32 v68, v68, v16
  v_mul_f32 v69, v69, v16
  v_mul_f32 v70, v70, v16
  v_mul_f32 v71, v71, v16
  v_mul_f32 v76, v76, v16
  v_mul_f32 v77, v77, v16
  v_mul_f32 v78, v78, v16
  v_mul_f32 v79, v79, v16
  v_add_f32 v14, v14, v20
  v_add_f32 v14, v14, v21
  v_add_f32 v14, v14, v22
  v_add_f32 v14, v14, v23
  v_add_f32 v14, v14, v28
  v_add_f32 v14, v14, v29
  v_add_f32 v14, v14, v30
  v_add_f32 v14, v14, v31
  v_mul_f32 v15, v15, v17
  v_mul_f32 v72, v72, v17
  v_mul_f32 v73, v73, v17
  v_mul_f32 v74, v74, v17
  v_mul_f32 v75, v75, v17
  v_mul_f32 v80, v80, v17
  v_mul_f32 v81, v81, v17
  v_mul_f32 v82, v82, v17
  v_mul_f32 v83, v83, v17
  v_add_f32 v15, v15, v24
  v_add_f32 v15, v15, v25
  v_add_f32 v15, v15, v26
  v_add_f32 v15, v15, v27
  v_add_f32 v15, v15, v32
  v_add_f32 v15, v15, v33
  v_add_f32 v15, v15, v34
  v_add_f32 v15, v15, v35
  v_cvt_pk_bf16_f32 v52, v20, v21
  v_cvt_pk_bf16_f32 v53, v22, v23
  v_cvt_pk_bf16_f32 v54, v28, v29
  v_cvt_pk_bf16_f32 v55, v30, v31
  v_cvt_pk_bf16_f32 v56, v24, v25
  v_cvt_pk_bf16_f32 v57, v26, v27
  v_cvt_pk_bf16_f32 v58, v32, v33
  v_cvt_pk_bf16_f32 v59, v34, v35
  s_nop 1
  v_mfma_f32_16x16x32_bf16 v[68:71], v[112:115], v[52:55], v[68:71]
  v_mfma_f32_16x16x32_bf16 v[72:75], v[112:115], v[56:59], v[72:75]
  v_mfma_f32_16x16x32_bf16 v[76:79], v[116:119], v[52:55], v[76:79]
  v_mfma_f32_16x16x32_bf16 v[80:83], v[116:119], v[56:59], v[80:83]
  s_nop 15
  s_barrier
  s_sub_u32 s68, s68, 1
  s_cmp_lg_u32 s68, 0
  s_cbranch_scc1 L_at_sloop
  v_mov_b32 v84, v14
  v_mov_b32 v85, v84
  s_nop 1
  v_permlane16_swap_b32 v84, v85
  s_nop 1
  v_add_f32 v84, v84, v85
  v_mov_b32 v85, v84
  s_nop 1
  v_permlane32_swap_b32 v84, v85
  s_nop 1
  v_add_f32 v84, v84, v85
  v_mov_b32 v88, v15
  v_mov_b32 v89, v88
  s_nop 1
  v_permlane16_swap_b32 v88, v89
  s_nop 1
  v_add_f32 v88, v88, v89
  v_mov_b32 v89, v88
  s_nop 1
  v_permlane32_swap_b32 v88, v89
  s_nop 1
  v_add_f32 v88, v88, v89
  s_branch L_at_fin
L_mid_down:
  s_and_b32 s72, s2, 1
  s_lshl_b32 s72, s72, 3
  s_bfe_u32 s73, s2, 0x30003
  s_add_u32 s72, s72, s73
  s_lshl_b32 s69, s72, 7
  s_bfe_u32 s72, s2, 0x10001
  s_lshl_b32 s72, s72, 2
  s_lshr_b32 s73, s2, 6
  s_add_u32 s72, s72, s73
  s_lshl_b32 s70, s72, 7
  s_bfe_u32 s71, s2, 0x10002
  s_add_u32 s28, s24, 0xc00000
  s_addc_u32 s29, s25, 0
  s_mov_b32 s30, 0xe00000
  s_mov_b32 s31, 0x00020000
  s_mov_b32 s32, s16
  s_mov_b32 s33, s17
  s_mov_b32 s34, 0x700000
  s_mov_b32 s35, 0x00020000
  s_mul_i32 s79, s71, 7340032
  s_mul_i32 s78, s71, 3670016
  s_mov_b32 s64, 2048
  s_add_u32 s73, s52, 0
  s_lshr_b32 s74, s73, 2
  s_and_b32 s73, s73, 3
  s_lshl_b32 s73, s73, 3
  s_sub_u32 s73, s73, 32
  s_mul_i32 s73, s73, 2048
  s_lshl_b32 s74, s74, 7
  s_add_u32 s73, s73, s74
  s_lshl_b32 s74, s70, 1
  s_add_u32 s73, s73, s74
  s_add_u32 s60, s73, s78
  s_add_u32 s73, s52, 4
  s_lshr_b32 s74, s73, 2
  s_and_b32 s73, s73, 3
  s_lshl_b32 s73, s73, 3
  s_sub_u32 s73, s73, 32
  s_mul_i32 s73, s73, 2048
  s_lshl_b32 s74, s74, 7
  s_add_u32 s73, s73, s74
  s_lshl_b32 s74, s70, 1
  s_add_u32 s73, s73, s74
  s_add_u32 s61, s73, s78
  v_lshrrev_b32 v8, 3, v0
  v_bfe_u32 v9, v0, 4, 1
  s_and_b32 s77, s52, 1
  s_lshl_b32 s77, s77, 1
  v_or_b32 v9, s77, v9
  v_lshlrev_b32 v9, 1, v9
  v_xor_b32 v9, v0, v9
  v_and_b32 v9, 7, v9
  v_lshlrev_b32 v9, 4, v9
  v_mul_lo_u32 v2, v8, s64
  v_add_u32 v2, v2, v9
  s_lshl_b32 s64, s64, 5
  s_mul_i32 s72, s69, 64
  s_add_u32 s72, s72, s79
  v_lshrrev_b32 v8, 2, v0
  s_mov_b32 s77, 64
  v_mul_lo_u32 v1, v8, s77
  v_lshrrev_b32 v9, 4, v0
  v_sub_u32 v9, 0, v9
  v_xor_b32 v10, v0, v9
  v_and_b32 v10, 3, v10
  v_lshl_add_u32 v1, v10, 4, v1
  s_add_u32 s78, s52, 0
  s_mul_i32 s78, s78, 1024
  s_add_u32 s56, s78, s72
  s_sub_u32 s56, s56, 0x20000
  s_add_u32 s78, s52, 4
  s_mul_i32 s78, s78, 1024
  s_add_u32 s57, s78, s72
  s_sub_u32 s57, s57, 0x20000
  v_and_b32 v8, 15, v0
  v_lshrrev_b32 v9, 4, v0
  v_lshrrev_b32 v10, 2, v8
  v_sub_u32 v11, 0, v10
  v_xor_b32 v11, v11, v9
  v_and_b32 v11, 3, v11
  s_mul_i32 s77, s55, 4096
  v_lshlrev_b32 v12, 6, v8
  v_add_u32 v12, s77, v12
  v_lshl_add_u32 v3, v11, 4, v12
  v_bfe_u32 v8, v0, 2, 2
  v_lshl_add_u32 v10, v9, 3, v8
  v_lshlrev_b32 v10, 7, v10
  v_and_b32 v11, 3, v0
  v_lshl_add_u32 v10, v11, 3, v10
  v_add_u32 v10, 0x6000, v10
  v_bfe_u32 v11, v0, 3, 1
  v_bfe_u32 v12, v0, 4, 1
  v_lshl_or_b32 v11, v12, 1, v11
  s_mul_i32 s77, s54, 4096
  v_xor_b32 v12, 0, v11
  v_lshl_add_u32 v12, v12, 5, v10
  v_add_u32 v4, s77, v12
  v_xor_b32 v12, 1, v11
  v_lshl_add_u32 v12, v12, 5, v10
  v_add_u32 v5, s77, v12
  v_xor_b32 v12, 2, v11
  v_lshl_add_u32 v12, v12, 5, v10
  v_add_u32 v6, s77, v12
  v_xor_b32 v12, 3, v11
  v_lshl_add_u32 v12, v12, 5, v10
  v_add_u32 v7, s77, v12
  s_add_u32 m0, s53, 0x0
  s_add_u32 s56, s56, 0x20000
  buffer_load_dwordx4 v1, s[28:31], s56 offen lds
  s_add_u32 m0, s53, 0x1000
  s_add_u32 s57, s57, 0x20000
  buffer_load_dwordx4 v1, s[28:31], s57 offen lds
  s_add_u32 m0, s53, 0x6000
  s_add_u32 s60, s60, s64
  buffer_load_dwordx4 v2, s[32:35], s60 offen lds
  s_add_u32 m0, s53, 0x7000
  s_add_u32 s61, s61, s64
  buffer_load_dwordx4 v2, s[32:35], s61 offen lds
  s_add_u32 m0, s53, 0x2000
  s_add_u32 s56, s56, 0x20000
  buffer_load_dwordx4 v1, s[28:31], s56 offen lds
  s_add_u32 m0, s53, 0x3000
  s_add_u32 s57, s57, 0x20000
  buffer_load_dwordx4 v1, s[28:31], s57 offen lds
  s_add_u32 m0, s53, 0x8000
  s_add_u32 s60, s60, s64
  buffer_load_dwordx4 v2, s[32:35], s60 offen lds
  s_add_u32 m0, s53, 0x9000
  s_add_u32 s61, s61, s64
  buffer_load_dwordx4 v2, s[32:35], s61 offen lds
  s_add_u32 m0, s53, 0x4000
  s_add_u32 s56, s56, 0x20000
  buffer_load_dwordx4 v1, s[28:31], s56 offen lds
  s_add_u32 m0, s53, 0x5000
  s_add_u32 s57, s57, 0x20000
  buffer_load_dwordx4 v1, s[28:31], s57 offen lds
  s_add_u32 m0, s53, 0xa000
  s_add_u32 s60, s60, s64
  buffer_load_dwordx4 v2, s[32:35], s60 offen lds
  s_add_u32 m0, s53, 0xb000
  s_add_u32 s61, s61, s64
  buffer_load_dwordx4 v2, s[32:35], s61 offen lds
  v_mov_b32 v80, 0
  v_mov_b32 v81, 0
  v_mov_b32 v82, 0
  v_mov_b32 v83, 0
  v_mov_b32 v84, 0
  v_mov_b32 v85, 0
  v_mov_b32 v86, 0
  v_mov_b32 v87, 0
  v_mov_b32 v88, 0
  v_mov_b32 v89, 0
  v_mov_b32 v90, 0
  v_mov_b32 v91, 0
  v_mov_b32 v92, 0
  v_mov_b32 v93, 0
  v_mov_b32 v94, 0
  v_mov_b32 v95, 0
  v_mov_b32 v96, 0
  v_mov_b32 v97, 0
  v_mov_b32 v98, 0
  v_mov_b32 v99, 0
  v_mov_b32 v100, 0
  v_mov_b32 v101, 0
  v_mov_b32 v102, 0
  v_mov_b32 v103, 0
  v_mov_b32 v104, 0
  v_mov_b32 v105, 0
  v_mov_b32 v106, 0
  v_mov_b32 v107, 0
  v_mov_b32 v108, 0
  v_mov_b32 v109, 0
  v_mov_b32 v110, 0
  v_mov_b32 v111, 0
  v_mov_b32 v112, 0
  v_mov_b32 v113, 0
  v_mov_b32 v114, 0
  v_mov_b32 v115, 0
  v_mov_b32 v116, 0
  v_mov_b32 v117, 0
  v_mov_b32 v118, 0
  v_mov_b32 v119, 0
  v_mov_b32 v120, 0
  v_mov_b32 v121, 0
  v_mov_b32 v122, 0
  v_mov_b32 v123, 0
  v_mov_b32 v124, 0
  v_mov_b32 v125, 0
  v_mov_b32 v126, 0
  v_mov_b32 v127, 0
  v_mov_b32 v128, 0
  v_mov_b32 v129, 0
  v_mov_b32 v130, 0
  v_mov_b32 v131, 0
  v_mov_b32 v132, 0
  v_mov_b32 v133, 0
  v_mov_b32 v134, 0
  v_mov_b32 v135, 0
  v_mov_b32 v136, 0
  v_mov_b32 v137, 0
  v_mov_b32 v138, 0
  v_mov_b32 v139, 0
  v_mov_b32 v140, 0
  v_mov_b32 v141, 0
  v_mov_b32 v142, 0
  v_mov_b32 v143, 0
  s_waitcnt vmcnt(8)
  s_barrier
  ds_read_b128 v[48:51], v3 offset:0
  ds_read_b128 v[52:55], v3 offset:1024
  ds_read_b128 v[56:59], v3 offset:2048
  ds_read_b128 v[60:63], v3 offset:3072
  ds_read_b64_tr_b16 v[16:17], v4 offset:0
  ds_read_b64_tr_b16 v[18:19], v4 offset:512
  ds_read_b64_tr_b16 v[20:21], v5 offset:0
  ds_read_b64_tr_b16 v[22:23], v5 offset:512
  ds_read_b64_tr_b16 v[24:25], v6 offset:0
  ds_read_b64_tr_b16 v[26:27], v6 offset:512
  ds_read_b64_tr_b16 v[28:29], v7 offset:0
  ds_read_b64_tr_b16 v[30:31], v7 offset:512
  s_mov_b32 s68, 8
L_dn_loop:
  s_waitcnt vmcnt(4) lgkmcnt(0)
  s_barrier
  v_mfma_f32_16x16x32_bf16 v[80:83], v[16:19], v[48:51], v[80:83]
  ds_read_b128 v[64:67], v3 offset:8192
  ds_read_b64_tr_b16 v[32:33], v4 offset:8192
  v_mfma_f32_16x16x32_bf16 v[84:87], v[16:19], v[52:55], v[84:87]
  ds_read_b64_tr_b16 v[34:35], v4 offset:8704
  v_mfma_f32_16x16x32_bf16 v[88:91], v[16:19], v[56:59], v[88:91]
  ds_read_b128 v[68:71], v3 offset:9216
  ds_read_b128 v[72:75], v3 offset:10240
  v_mfma_f32_16x16x32_bf16 v[92:95], v[16:19], v[60:63], v[92:95]
  ds_read_b128 v[76:79], v3 offset:11264
  v_mfma_f32_16x16x32_bf16 v[96:99], v[20:23], v[48:51], v[96:99]
  ds_read_b64_tr_b16 v[36:37], v5 offset:8192
  ds_read_b64_tr_b16 v[38:39], v5 offset:8704
  v_mfma_f32_16x16x32_bf16 v[100:103], v[20:23], v[52:55], v[100:103]
  ds_read_b64_tr_b16 v[40:41], v6 offset:8192
  v_mfma_f32_16x16x32_bf16 v[104:107], v[20:23], v[56:59], v[104:107]
  ds_read_b64_tr_b16 v[42:43], v6 offset:8704
  ds_read_b64_tr_b16 v[44:45], v7 offset:8192
  v_mfma_f32_16x16x32_bf16 v[108:111], v[20:23], v[60:63], v[108:111]
  ds_read_b64_tr_b16 v[46:47], v7 offset:8704
  v_mfma_f32_16x16x32_bf16 v[112:115], v[24:27], v[48:51], v[112:115]
  s_add_u32 m0, s53, 0x0
  s_add_u32 s56, s56, 0x20000
  v_mfma_f32_16x16x32_bf16 v[116:119], v[24:27], v[52:55], v[116:119]
  buffer_load_dwordx4 v1, s[28:31], s56 offen lds
  v_mfma_f32_16x16x32_bf16 v[120:123], v[24:27], v[56:59], v[120:123]
  s_add_u32 m0, s53, 0x1000
  s_add_u32 s57, s57, 0x20000
  v_mfma_f32_16x16x32_bf16 v[124:127], v[24:27], v[60:63], v[124:127]
  buffer_load_dwordx4 v1, s[28:31], s57 offen lds
  v_mfma_f32_16x16x32_bf16 v[128:131], v[28:31], v[48:51], v[128:131]
  s_add_u32 m0, s53, 0x6000
  s_add_u32 s60, s60, s64
  v_mfma_f32_16x16x32_bf16 v[132:135], v[28:31], v[52:55], v[132:135]
  buffer_load_dwordx4 v2, s[32:35], s60 offen lds
  v_mfma_f32_16x16x32_bf16 v[136:139], v[28:31], v[56:59], v[136:139]
  s_add_u32 m0, s53, 0x7000
  s_add_u32 s61, s61, s64
  v_mfma_f32_16x16x32_bf16 v[140:143], v[28:31], v[60:63], v[140:143]
  buffer_load_dwordx4 v2, s[32:35], s61 offen lds
  s_waitcnt vmcnt(4) lgkmcnt(0)
  s_barrier
  v_mfma_f32_16x16x32_bf16 v[80:83], v[32:35], v[64:67], v[80:83]
  ds_read_b128 v[48:51], v3 offset:16384
  ds_read_b64_tr_b16 v[16:17], v4 offset:16384
  v_mfma_f32_16x16x32_bf16 v[84:87], v[32:35], v[68:71], v[84:87]
  ds_read_b64_tr_b16 v[18:19], v4 offset:16896
  v_mfma_f32_16x16x32_bf16 v[88:91], v[32:35], v[72:75], v[88:91]
  ds_read_b128 v[52:55], v3 offset:17408
  ds_read_b128 v[56:59], v3 offset:18432
  v_mfma_f32_16x16x32_bf16 v[92:95], v[32:35], v[76:79], v[92:95]
  ds_read_b128 v[60:63], v3 offset:19456
  v_mfma_f32_16x16x32_bf16 v[96:99], v[36:39], v[64:67], v[96:99]
  ds_read_b64_tr_b16 v[20:21], v5 offset:16384
  ds_read_b64_tr_b16 v[22:23], v5 offset:16896
  v_mfma_f32_16x16x32_bf16 v[100:103], v[36:39], v[68:71], v[100:103]
  ds_read_b64_tr_b16 v[24:25], v6 offset:16384
  v_mfma_f32_16x16x32_bf16 v[104:107], v[36:39], v[72:75], v[104:107]
  ds_read_b64_tr_b16 v[26:27], v6 offset:16896
  ds_read_b64_tr_b16 v[28:29], v7 offset:16384
  v_mfma_f32_16x16x32_bf16 v[108:111], v[36:39], v[76:79], v[108:111]
  ds_read_b64_tr_b16 v[30:31], v7 offset:16896
  v_mfma_f32_16x16x32_bf16 v[112:115], v[40:43], v[64:67], v[112:115]
  s_add_u32 m0, s53, 0x2000
  s_add_u32 s56, s56, 0x20000
  v_mfma_f32_16x16x32_bf16 v[116:119], v[40:43], v[68:71], v[116:119]
  buffer_load_dwordx4 v1, s[28:31], s56 offen lds
  v_mfma_f32_16x16x32_bf16 v[120:123], v[40:43], v[72:75], v[120:123]
  s_add_u32 m0, s53, 0x3000
  s_add_u32 s57, s57, 0x20000
  v_mfma_f32_16x16x32_bf16 v[124:127], v[40:43], v[76:79], v[124:127]
  buffer_load_dwordx4 v1, s[28:31], s57 offen lds
  v_mfma_f32_16x16x32_bf16 v[128:131], v[44:47], v[64:67], v[128:131]
  s_add_u32 m0, s53, 0x8000
  s_add_u32 s60, s60, s64
  v_mfma_f32_16x16x32_bf16 v[132:135], v[44:47], v[68:71], v[132:135]
  buffer_load_dwordx4 v2, s[32:35], s60 offen lds
  v_mfma_f32_16x16x32_bf16 v[136:139], v[44:47], v[72:75], v[136:139]
  s_add_u32 m0, s53, 0x9000
  s_add_u32 s61, s61, s64
  v_mfma_f32_16x16x32_bf16 v[140:143], v[44:47], v[76:79], v[140:143]
  buffer_load_dwordx4 v2, s[32:35], s61 offen lds
  s_waitcnt vmcnt(4) lgkmcnt(0)
  s_barrier
  v_mfma_f32_16x16x32_bf16 v[80:83], v[16:19], v[48:51], v[80:83]
  ds_read_b128 v[64:67], v3 offset:0
  ds_read_b64_tr_b16 v[32:33], v4 offset:0
  v_mfma_f32_16x16x32_bf16 v[84:87], v[16:19], v[52:55], v[84:87]
  ds_read_b64_tr_b16 v[34:35], v4 offset:512
  v_mfma_f32_16x16x32_bf16 v[88:91], v[16:19], v[56:59], v[88:91]
  ds_read_b128 v[68:71], v3 offset:1024
  ds_read_b128 v[72:75], v3 offset:2048
  v_mfma_f32_16x16x32_bf16 v[92:95], v[16:19], v[60:63], v[92:95]
  ds_read_b128 v[76:79], v3 offset:3072
  v_mfma_f32_16x16x32_bf16 v[96:99], v[20:23], v[48:51], v[96:99]
  ds_read_b64_tr_b16 v[36:37], v5 offset:0
  ds_read_b64_tr_b16 v[38:39], v5 offset:512
  v_mfma_f32_16x16x32_bf16 v[100:103], v[20:23], v[52:55], v[100:103]
  ds_read_b64_tr_b16 v[40:41], v6 offset:0
  v_mfma_f32_16x16x32_bf16 v[104:107], v[20:23], v[56:59], v[104:107]
  ds_read_b64_tr_b16 v[42:43], v6 offset:512
  ds_read_b64_tr_b16 v[44:45], v7 offset:0
  v_mfma_f32_16x16x32_bf16 v[108:111], v[20:23], v[60:63], v[108:111]
  ds_read_b64_tr_b16 v[46:47], v7 offset:512
  v_mfma_f32_16x16x32_bf16 v[112:115], v[24:27], v[48:51], v[112:115]
  s_add_u32 m0, s53, 0x4000
  s_add_u32 s56, s56, 0x20000
  v_mfma_f32_16x16x32_bf16 v[116:119], v[24:27], v[52:55], v[116:119]
  buffer_load_dwordx4 v1, s[28:31], s56 offen lds
  v_mfma_f32_16x16x32_bf16 v[120:123], v[24:27], v[56:59], v[120:123]
  s_add_u32 m0, s53, 0x5000
  s_add_u32 s57, s57, 0x20000
  v_mfma_f32_16x16x32_bf16 v[124:127], v[24:27], v[60:63], v[124:127]
  buffer_load_dwordx4 v1, s[28:31], s57 offen lds
  v_mfma_f32_16x16x32_bf16 v[128:131], v[28:31], v[48:51], v[128:131]
  s_add_u32 m0, s53, 0xa000
  s_add_u32 s60, s60, s64
  v_mfma_f32_16x16x32_bf16 v[132:135], v[28:31], v[52:55], v[132:135]
  buffer_load_dwordx4 v2, s[32:35], s60 offen lds
  v_mfma_f32_16x16x32_bf16 v[136:139], v[28:31], v[56:59], v[136:139]
  s_add_u32 m0, s53, 0xb000
  s_add_u32 s61, s61, s64
  v_mfma_f32_16x16x32_bf16 v[140:143], v[28:31], v[60:63], v[140:143]
  buffer_load_dwordx4 v2, s[32:35], s61 offen lds
  s_waitcnt vmcnt(4) lgkmcnt(0)
  s_barrier
  v_mfma_f32_16x16x32_bf16 v[80:83], v[32:35], v[64:67], v[80:83]
  ds_read_b128 v[48:51], v3 offset:8192
  ds_read_b64_tr_b16 v[16:17], v4 offset:8192
  v_mfma_f32_16x16x32_bf16 v[84:87], v[32:35], v[68:71], v[84:87]
  ds_read_b64_tr_b16 v[18:19], v4 offset:8704
  v_mfma_f32_16x16x32_bf16 v[88:91], v[32:35], v[72:75], v[88:91]
  ds_read_b128 v[52:55], v3 offset:9216
  ds_read_b128 v[56:59], v3 offset:10240
  v_mfma_f32_16x16x32_bf16 v[92:95], v[32:35], v[76:79], v[92:95]
  ds_read_b128 v[60:63], v3 offset:11264
  v_mfma_f32_16x16x32_bf16 v[96:99], v[36:39], v[64:67], v[96:99]
  ds_read_b64_tr_b16 v[20:21], v5 offset:8192
  ds_read_b64_tr_b16 v[22:23], v5 offset:8704
  v_mfma_f32_16x16x32_bf16 v[100:103], v[36:39], v[68:71], v[100:103]
  ds_read_b64_tr_b16 v[24:25], v6 offset:8192
  v_mfma_f32_16x16x32_bf16 v[104:107], v[36:39], v[72:75], v[104:107]
  ds_read_b64_tr_b16 v[26:27], v6 offset:8704
  ds_read_b64_tr_b16 v[28:29], v7 offset:8192
  v_mfma_f32_16x16x32_bf16 v[108:111], v[36:39], v[76:79], v[108:111]
  ds_read_b64_tr_b16 v[30:31], v7 offset:8704
  v_mfma_f32_16x16x32_bf16 v[112:115], v[40:43], v[64:67], v[112:115]
  s_add_u32 m0, s53, 0x0
  s_add_u32 s56, s56, 0x20000
  v_mfma_f32_16x16x32_bf16 v[116:119], v[40:43], v[68:71], v[116:119]
  buffer_load_dwordx4 v1, s[28:31], s56 offen lds
  v_mfma_f32_16x16x32_bf16 v[120:123], v[40:43], v[72:75], v[120:123]
  s_add_u32 m0, s53, 0x1000
  s_add_u32 s57, s57, 0x20000
  v_mfma_f32_16x16x32_bf16 v[124:127], v[40:43], v[76:79], v[124:127]
  buffer_load_dwordx4 v1, s[28:31], s57 offen lds
  v_mfma_f32_16x16x32_bf16 v[128:131], v[44:47], v[64:67], v[128:131]
  s_add_u32 m0, s53, 0x6000
  s_add_u32 s60, s60, s64
  v_mfma_f32_16x16x32_bf16 v[132:135], v[44:47], v[68:71], v[132:135]
  buffer_load_dwordx4 v2, s[32:35], s60 offen lds
  v_mfma_f32_16x16x32_bf16 v[136:139], v[44:47], v[72:75], v[136:139]
  s_add_u32 m0, s53, 0x7000
  s_add_u32 s61, s61, s64
  v_mfma_f32_16x16x32_bf16 v[140:143], v[44:47], v[76:79], v[140:143]
  buffer_load_dwordx4 v2, s[32:35], s61 offen lds
  s_waitcnt vmcnt(4) lgkmcnt(0)
  s_barrier
  v_mfma_f32_16x16x32_bf16 v[80:83], v[16:19], v[48:51], v[80:83]
  ds_read_b128 v[64:67], v3 offset:16384
  ds_read_b64_tr_b16 v[32:33], v4 offset:16384
  v_mfma_f32_16x16x32_bf16 v[84:87], v[16:19], v[52:55], v[84:87]
  ds_read_b64_tr_b16 v[34:35], v4 offset:16896
  v_mfma_f32_16x16x32_bf16 v[88:91], v[16:19], v[56:59], v[88:91]
  ds_read_b128 v[68:71], v3 offset:17408
  ds_read_b128 v[72:75], v3 offset:18432
  v_mfma_f32_16x16x32_bf16 v[92:95], v[16:19], v[60:63], v[92:95]
  ds_read_b128 v[76:79], v3 offset:19456
  v_mfma_f32_16x16x32_bf16 v[96:99], v[20:23], v[48:51], v[96:99]
  ds_read_b64_tr_b16 v[36:37], v5 offset:16384
  ds_read_b64_tr_b16 v[38:39], v5 offset:16896
  v_mfma_f32_16x16x32_bf16 v[100:103], v[20:23], v[52:55], v[100:103]
  ds_read_b64_tr_b16 v[40:41], v6 offset:16384
  v_mfma_f32_16x16x32_bf16 v[104:107], v[20:23], v[56:59], v[104:107]
  ds_read_b64_tr_b16 v[42:43], v6 offset:16896
  ds_read_b64_tr_b16 v[44:45], v7 offset:16384
  v_mfma_f32_16x16x32_bf16 v[108:111], v[20:23], v[60:63], v[108:111]
  ds_read_b64_tr_b16 v[46:47], v7 offset:16896
  v_mfma_f32_16x16x32_bf16 v[112:115], v[24:27], v[48:51], v[112:115]
  s_add_u32 m0, s53, 0x2000
  s_add_u32 s56, s56, 0x20000
  v_mfma_f32_16x16x32_bf16 v[116:119], v[24:27], v[52:55], v[116:119]
  buffer_load_dwordx4 v1, s[28:31], s56 offen lds
  v_mfma_f32_16x16x32_bf16 v[120:123], v[24:27], v[56:59], v[120:123]
  s_add_u32 m0, s53, 0x3000
  s_add_u32 s57, s57, 0x20000
  v_mfma_f32_16x16x32_bf16 v[124:127], v[24:27], v[60:63], v[124:127]
  buffer_load_dwordx4 v1, s[28:31], s57 offen lds
  v_mfma_f32_16x16x32_bf16 v[128:131], v[28:31], v[48:51], v[128:131]
  s_add_u32 m0, s53, 0x8000
  s_add_u32 s60, s60, s64
  v_mfma_f32_16x16x32_bf16 v[132:135], v[28:31], v[52:55], v[132:135]
  buffer_load_dwordx4 v2, s[32:35], s60 offen lds
  v_mfma_f32_16x16x32_bf16 v[136:139], v[28:31], v[56:59], v[136:139]
  s_add_u32 m0, s53, 0x9000
  s_add_u32 s61, s61, s64
  v_mfma_f32_16x16x32_bf16 v[140:143], v[28:31], v[60:63], v[140:143]
  buffer_load_dwordx4 v2, s[32:35], s61 offen lds
  s_waitcnt vmcnt(4) lgkmcnt(0)
  s_barrier
  v_mfma_f32_16x16x32_bf16 v[80:83], v[32:35], v[64:67], v[80:83]
  ds_read_b128 v[48:51], v3 offset:0
  ds_read_b64_tr_b16 v[16:17], v4 offset:0
  v_mfma_f32_16x16x32_bf16 v[84:87], v[32:35], v[68:71], v[84:87]
  ds_read_b64_tr_b16 v[18:19], v4 offset:512
  v_mfma_f32_16x16x32_bf16 v[88:91], v[32:35], v[72:75], v[88:91]
  ds_read_b128 v[52:55], v3 offset:1024
  ds_read_b128 v[56:59], v3 offset:2048
  v_mfma_f32_16x16x32_bf16 v[92:95], v[32:35], v[76:79], v[92:95]
  ds_read_b128 v[60:63], v3 offset:3072
  v_mfma_f32_16x16x32_bf16 v[96:99], v[36:39], v[64:67], v[96:99]
  ds_read_b64_tr_b16 v[20:21], v5 offset:0
  ds_read_b64_tr_b16 v[22:23], v5 offset:512
  v_mfma_f32_16x16x32_bf16 v[100:103], v[36:39], v[68:71], v[100:103]
  ds_read_b64_tr_b16 v[24:25], v6 offset:0
  v_mfma_f32_16x16x32_bf16 v[104:107], v[36:39], v[72:75], v[104:107]
  ds_read_b64_tr_b16 v[26:27], v6 offset:512
  ds_read_b64_tr_b16 v[28:29], v7 offset:0
  v_mfma_f32_16x16x32_bf16 v[108:111], v[36:39], v[76:79], v[108:111]
  ds_read_b64_tr_b16 v[30:31], v7 offset:512
  v_mfma_f32_16x16x32_bf16 v[112:115], v[40:43], v[64:67], v[112:115]
  s_add_u32 m0, s53, 0x4000
  s_add_u32 s56, s56, 0x20000
  v_mfma_f32_16x16x32_bf16 v[116:119], v[40:43], v[68:71], v[116:119]
  buffer_load_dwordx4 v1, s[28:31], s56 offen lds
  v_mfma_f32_16x16x32_bf16 v[120:123], v[40:43], v[72:75], v[120:123]
  s_add_u32 m0, s53, 0x5000
  s_add_u32 s57, s57, 0x20000
  v_mfma_f32_16x16x32_bf16 v[124:127], v[40:43], v[76:79], v[124:127]
  buffer_load_dwordx4 v1, s[28:31], s57 offen lds
  v_mfma_f32_16x16x32_bf16 v[128:131], v[44:47], v[64:67], v[128:131]
  s_add_u32 m0, s53, 0xa000
  s_add_u32 s60, s60, s64
  v_mfma_f32_16x16x32_bf16 v[132:135], v[44:47], v[68:71], v[132:135]
  buffer_load_dwordx4 v2, s[32:35], s60 offen lds
  v_mfma_f32_16x16x32_bf16 v[136:139], v[44:47], v[72:75], v[136:139]
  s_add_u32 m0, s53, 0xb000
  s_add_u32 s61, s61, s64
  v_mfma_f32_16x16x32_bf16 v[140:143], v[44:47], v[76:79], v[140:143]
  buffer_load_dwordx4 v2, s[32:35], s61 offen lds
  s_sub_u32 s68, s68, 1
  s_cmp_lg_u32 s68, 0
  s_cbranch_scc1 L_dn_loop
  s_waitcnt vmcnt(4) lgkmcnt(0)
  s_barrier
  v_mfma_f32_16x16x32_bf16 v[80:83], v[16:19], v[48:51], v[80:83]
  ds_read_b128 v[64:67], v3 offset:8192
  ds_read_b64_tr_b16 v[32:33], v4 offset:8192
  v_mfma_f32_16x16x32_bf16 v[84:87], v[16:19], v[52:55], v[84:87]
  ds_read_b64_tr_b16 v[34:35], v4 offset:8704
  v_mfma_f32_16x16x32_bf16 v[88:91], v[16:19], v[56:59], v[88:91]
  ds_read_b128 v[68:71], v3 offset:9216
  ds_read_b128 v[72:75], v3 offset:10240
  v_mfma_f32_16x16x32_bf16 v[92:95], v[16:19], v[60:63], v[92:95]
  ds_read_b128 v[76:79], v3 offset:11264
  v_mfma_f32_16x16x32_bf16 v[96:99], v[20:23], v[48:51], v[96:99]
  ds_read_b64_tr_b16 v[36:37], v5 offset:8192
  ds_read_b64_tr_b16 v[38:39], v5 offset:8704
  v_mfma_f32_16x16x32_bf16 v[100:103], v[20:23], v[52:55], v[100:103]
  ds_read_b64_tr_b16 v[40:41], v6 offset:8192
  v_mfma_f32_16x16x32_bf16 v[104:107], v[20:23], v[56:59], v[104:107]
  ds_read_b64_tr_b16 v[42:43], v6 offset:8704
  ds_read_b64_tr_b16 v[44:45], v7 offset:8192
  v_mfma_f32_16x16x32_bf16 v[108:111], v[20:23], v[60:63], v[108:111]
  ds_read_b64_tr_b16 v[46:47], v7 offset:8704
  v_mfma_f32_16x16x32_bf16 v[112:115], v[24:27], v[48:51], v[112:115]
  s_add_u32 m0, s53, 0x0
  s_add_u32 s56, s56, 0x20000
  v_mfma_f32_16x16x32_bf16 v[116:119], v[24:27], v[52:55], v[116:119]
  buffer_load_dwordx4 v1, s[28:31], s56 offen lds
  v_mfma_f32_16x16x32_bf16 v[120:123], v[24:27], v[56:59], v[120:123]
  s_add_u32 m0, s53, 0x1000
  s_add_u32 s57, s57, 0x20000
  v_mfma_f32_16x16x32_bf16 v[124:127], v[24:27], v[60:63], v[124:127]
  buffer_load_dwordx4 v1, s[28:31], s57 offen lds
  v_mfma_f32_16x16x32_bf16 v[128:131], v[28:31], v[48:51], v[128:131]
  s_add_u32 m0, s53, 0x6000
  s_add_u32 s60, s60, s64
  v_mfma_f32_16x16x32_bf16 v[132:135], v[28:31], v[52:55], v[132:135]
  buffer_load_dwordx4 v2, s[32:35], s60 offen lds
  v_mfma_f32_16x16x32_bf16 v[136:139], v[28:31], v[56:59], v[136:139]
  s_add_u32 m0, s53, 0x7000
  s_add_u32 s61, s61, s64
  v_mfma_f32_16x16x32_bf16 v[140:143], v[28:31], v[60:63], v[140:143]
  buffer_load_dwordx4 v2, s[32:35], s61 offen lds
  s_waitcnt vmcnt(4) lgkmcnt(0)
  s_barrier
  v_mfma_f32_16x16x32_bf16 v[80:83], v[32:35], v[64:67], v[80:83]
  ds_read_b128 v[48:51], v3 offset:16384
  ds_read_b64_tr_b16 v[16:17], v4 offset:16384
  v_mfma_f32_16x16x32_bf16 v[84:87], v[32:35], v[68:71], v[84:87]
  ds_read_b64_tr_b16 v[18:19], v4 offset:16896
  v_mfma_f32_16x16x32_bf16 v[88:91], v[32:35], v[72:75], v[88:91]
  ds_read_b128 v[52:55], v3 offset:17408
  ds_read_b128 v[56:59], v3 offset:18432
  v_mfma_f32_16x16x32_bf16 v[92:95], v[32:35], v[76:79], v[92:95]
  ds_read_b128 v[60:63], v3 offset:19456
  v_mfma_f32_16x16x32_bf16 v[96:99], v[36:39], v[64:67], v[96:99]
  ds_read_b64_tr_b16 v[20:21], v5 offset:16384
  ds_read_b64_tr_b16 v[22:23], v5 offset:16896
  v_mfma_f32_16x16x32_bf16 v[100:103], v[36:39], v[68:71], v[100:103]
  ds_read_b64_tr_b16 v[24:25], v6 offset:16384
  v_mfma_f32_16x16x32_bf16 v[104:107], v[36:39], v[72:75], v[104:107]
  ds_read_b64_tr_b16 v[26:27], v6 offset:16896
  ds_read_b64_tr_b16 v[28:29], v7 offset:16384
  v_mfma_f32_16x16x32_bf16 v[108:111], v[36:39], v[76:79], v[108:111]
  ds_read_b64_tr_b16 v[30:31], v7 offset:16896
  v_mfma_f32_16x16x32_bf16 v[112:115], v[40:43], v[64:67], v[112:115]
  s_add_u32 m0, s53, 0x2000
  s_add_u32 s56, s56, 0x20000
  v_mfma_f32_16x16x32_bf16 v[116:119], v[40:43], v[68:71], v[116:119]
  buffer_load_dwordx4 v1, s[28:31], s56 offen lds
  v_mfma_f32_16x16x32_bf16 v[120:123], v[40:43], v[72:75], v[120:123]
  s_add_u32 m0, s53, 0x3000
  s_add_u32 s57, s57, 0x20000
  v_mfma_f32_16x16x32_bf16 v[124:127], v[40:43], v[76:79], v[124:127]
  buffer_load_dwordx4 v1, s[28:31], s57 offen lds
  v_mfma_f32_16x16x32_bf16 v[128:131], v[44:47], v[64:67], v[128:131]
  s_add_u32 m0, s53, 0x8000
  s_add_u32 s60, s60, s64
  v_mfma_f32_16x16x32_bf16 v[132:135], v[44:47], v[68:71], v[132:135]
  buffer_load_dwordx4 v2, s[32:35], s60 offen lds
  v_mfma_f32_16x16x32_bf16 v[136:139], v[44:47], v[72:75], v[136:139]
  s_add_u32 m0, s53, 0x9000
  s_add_u32 s61, s61, s64
  v_mfma_f32_16x16x32_bf16 v[140:143], v[44:47], v[76:79], v[140:143]
  buffer_load_dwordx4 v2, s[32:35], s61 offen lds
  s_waitcnt vmcnt(4) lgkmcnt(0)
  s_barrier
  v_mfma_f32_16x16x32_bf16 v[80:83], v[16:19], v[48:51], v[80:83]
  ds_read_b128 v[64:67], v3 offset:0
  ds_read_b64_tr_b16 v[32:33], v4 offset:0
  v_mfma_f32_16x16x32_bf16 v[84:87], v[16:19], v[52:55], v[84:87]
  ds_read_b64_tr_b16 v[34:35], v4 offset:512
  v_mfma_f32_16x16x32_bf16 v[88:91], v[16:19], v[56:59], v[88:91]
  ds_read_b128 v[68:71], v3 offset:1024
  ds_read_b128 v[72:75], v3 offset:2048
  v_mfma_f32_16x16x32_bf16 v[92:95], v[16:19], v[60:63], v[92:95]
  ds_read_b128 v[76:79], v3 offset:3072
  v_mfma_f32_16x16x32_bf16 v[96:99], v[20:23], v[48:51], v[96:99]
  ds_read_b64_tr_b16 v[36:37], v5 offset:0
  ds_read_b64_tr_b16 v[38:39], v5 offset:512
  v_mfma_f32_16x16x32_bf16 v[100:103], v[20:23], v[52:55], v[100:103]
  ds_read_b64_tr_b16 v[40:41], v6 offset:0
  v_mfma_f32_16x16x32_bf16 v[104:107], v[20:23], v[56:59], v[104:107]
  ds_read_b64_tr_b16 v[42:43], v6 offset:512
  ds_read_b64_tr_b16 v[44:45], v7 offset:0
  v_mfma_f32_16x16x32_bf16 v[108:111], v[20:23], v[60:63], v[108:111]
  ds_read_b64_tr_b16 v[46:47], v7 offset:512
  v_mfma_f32_16x16x32_bf16 v[112:115], v[24:27], v[48:51], v[112:115]
  s_add_u32 m0, s53, 0x4000
  s_add_u32 s56, s56, 0x20000
  v_mfma_f32_16x16x32_bf16 v[116:119], v[24:27], v[52:55], v[116:119]
  buffer_load_dwordx4 v1, s[28:31], s56 offen lds
  v_mfma_f32_16x16x32_bf16 v[120:123], v[24:27], v[56:59], v[120:123]
  s_add_u32 m0, s53, 0x5000
  s_add_u32 s57, s57, 0x20000
  v_mfma_f32_16x16x32_bf16 v[124:127], v[24:27], v[60:63], v[124:127]
  buffer_load_dwordx4 v1, s[28:31], s57 offen lds
  v_mfma_f32_16x16x32_bf16 v[128:131], v[28:31], v[48:51], v[128:131]
  s_add_u32 m0, s53, 0xa000
  s_add_u32 s60, s60, s64
  v_mfma_f32_16x16x32_bf16 v[132:135], v[28:31], v[52:55], v[132:135]
  buffer_load_dwordx4 v2, s[32:35], s60 offen lds
  v_mfma_f32_16x16x32_bf16 v[136:139], v[28:31], v[56:59], v[136:139]
  s_add_u32 m0, s53, 0xb000
  s_add_u32 s61, s61, s64
  v_mfma_f32_16x16x32_bf16 v[140:143], v[28:31], v[60:63], v[140:143]
  buffer_load_dwordx4 v2, s[32:35], s61 offen lds
  s_waitcnt vmcnt(4) lgkmcnt(0)
  s_barrier
  v_mfma_f32_16x16x32_bf16 v[80:83], v[32:35], v[64:67], v[80:83]
  ds_read_b128 v[48:51], v3 offset:8192
  ds_read_b64_tr_b16 v[16:17], v4 offset:8192
  v_mfma_f32_16x16x32_bf16 v[84:87], v[32:35], v[68:71], v[84:87]
  ds_read_b64_tr_b16 v[18:19], v4 offset:8704
  v_mfma_f32_16x16x32_bf16 v[88:91], v[32:35], v[72:75], v[88:91]
  ds_read_b128 v[52:55], v3 offset:9216
  ds_read_b128 v[56:59], v3 offset:10240
  v_mfma_f32_16x16x32_bf16 v[92:95], v[32:35], v[76:79], v[92:95]
  ds_read_b128 v[60:63], v3 offset:11264
  v_mfma_f32_16x16x32_bf16 v[96:99], v[36:39], v[64:67], v[96:99]
  ds_read_b64_tr_b16 v[20:21], v5 offset:8192
  ds_read_b64_tr_b16 v[22:23], v5 offset:8704
  v_mfma_f32_16x16x32_bf16 v[100:103], v[36:39], v[68:71], v[100:103]
  ds_read_b64_tr_b16 v[24:25], v6 offset:8192
  v_mfma_f32_16x16x32_bf16 v[104:107], v[36:39], v[72:75], v[104:107]
  ds_read_b64_tr_b16 v[26:27], v6 offset:8704
  ds_read_b64_tr_b16 v[28:29], v7 offset:8192
  v_mfma_f32_16x16x32_bf16 v[108:111], v[36:39], v[76:79], v[108:111]
  ds_read_b64_tr_b16 v[30:31], v7 offset:8704
  v_mfma_f32_16x16x32_bf16 v[112:115], v[40:43], v[64:67], v[112:115]
  s_add_u32 m0, s53, 0x0
  s_add_u32 s56, s56, 0x20000
  v_mfma_f32_16x16x32_bf16 v[116:119], v[40:43], v[68:71], v[116:119]
  buffer_load_dwordx4 v1, s[28:31], s56 offen lds
  v_mfma_f32_16x16x32_bf16 v[120:123], v[40:43], v[72:75], v[120:123]
  s_add_u32 m0, s53, 0x1000
  s_add_u32 s57, s57, 0x20000
  v_mfma_f32_16x16x32_bf16 v[124:127], v[40:43], v[76:79], v[124:127]
  buffer_load_dwordx4 v1, s[28:31], s57 offen lds
  v_mfma_f32_16x16x32_bf16 v[128:131], v[44:47], v[64:67], v[128:131]
  s_add_u32 m0, s53, 0x6000
  s_add_u32 s60, s60, s64
  v_mfma_f32_16x16x32_bf16 v[132:135], v[44:47], v[68:71], v[132:135]
  buffer_load_dwordx4 v2, s[32:35], s60 offen lds
  v_mfma_f32_16x16x32_bf16 v[136:139], v[44:47], v[72:75], v[136:139]
  s_add_u32 m0, s53, 0x7000
  s_add_u32 s61, s61, s64
  v_mfma_f32_16x16x32_bf16 v[140:143], v[44:47], v[76:79], v[140:143]
  buffer_load_dwordx4 v2, s[32:35], s61 offen lds
  s_waitcnt vmcnt(4) lgkmcnt(0)
  s_barrier
  v_mfma_f32_16x16x32_bf16 v[80:83], v[16:19], v[48:51], v[80:83]
  ds_read_b128 v[64:67], v3 offset:16384
  ds_read_b64_tr_b16 v[32:33], v4 offset:16384
  v_mfma_f32_16x16x32_bf16 v[84:87], v[16:19], v[52:55], v[84:87]
  ds_read_b64_tr_b16 v[34:35], v4 offset:16896
  v_mfma_f32_16x16x32_bf16 v[88:91], v[16:19], v[56:59], v[88:91]
  ds_read_b128 v[68:71], v3 offset:17408
  ds_read_b128 v[72:75], v3 offset:18432
  v_mfma_f32_16x16x32_bf16 v[92:95], v[16:19], v[60:63], v[92:95]
  ds_read_b128 v[76:79], v3 offset:19456
  v_mfma_f32_16x16x32_bf16 v[96:99], v[20:23], v[48:51], v[96:99]
  ds_read_b64_tr_b16 v[36:37], v5 offset:16384
  ds_read_b64_tr_b16 v[38:39], v5 offset:16896
  v_mfma_f32_16x16x32_bf16 v[100:103], v[20:23], v[52:55], v[100:103]
  ds_read_b64_tr_b16 v[40:41], v6 offset:16384
  v_mfma_f32_16x16x32_bf16 v[104:107], v[20:23], v[56:59], v[104:107]
  ds_read_b64_tr_b16 v[42:43], v6 offset:16896
  ds_read_b64_tr_b16 v[44:45], v7 offset:16384
  v_mfma_f32_16x16x32_bf16 v[108:111], v[20:23], v[60:63], v[108:111]
  ds_read_b64_tr_b16 v[46:47], v7 offset:16896
  v_mfma_f32_16x16x32_bf16 v[112:115], v[24:27], v[48:51], v[112:115]
  s_add_u32 m0, s53, 0x2000
  s_add_u32 s56, s56, 0x20000
  v_mfma_f32_16x16x32_bf16 v[116:119], v[24:27], v[52:55], v[116:119]
  buffer_load_dwordx4 v1, s[28:31], s56 offen lds
  v_mfma_f32_16x16x32_bf16 v[120:123], v[24:27], v[56:59], v[120:123]
  s_add_u32 m0, s53, 0x3000
  s_add_u32 s57, s57, 0x20000
  v_mfma_f32_16x16x32_bf16 v[124:127], v[24:27], v[60:63], v[124:127]
  buffer_load_dwordx4 v1, s[28:31], s57 offen lds
  v_mfma_f32_16x16x32_bf16 v[128:131], v[28:31], v[48:51], v[128:131]
  s_add_u32 m0, s53, 0x8000
  s_add_u32 s60, s60, s64
  v_mfma_f32_16x16x32_bf16 v[132:135], v[28:31], v[52:55], v[132:135]
  buffer_load_dwordx4 v2, s[32:35], s60 offen lds
  v_mfma_f32_16x16x32_bf16 v[136:139], v[28:31], v[56:59], v[136:139]
  s_add_u32 m0, s53, 0x9000
  s_add_u32 s61, s61, s64
  v_mfma_f32_16x16x32_bf16 v[140:143], v[28:31], v[60:63], v[140:143]
  buffer_load_dwordx4 v2, s[32:35], s61 offen lds
  s_waitcnt vmcnt(4) lgkmcnt(0)
  s_barrier
  v_mfma_f32_16x16x32_bf16 v[80:83], v[32:35], v[64:67], v[80:83]
  ds_read_b128 v[48:51], v3 offset:0
  v_mfma_f32_16x16x32_bf16 v[84:87], v[32:35], v[68:71], v[84:87]
  ds_read_b64_tr_b16 v[16:17], v4 offset:0
  v_mfma_f32_16x16x32_bf16 v[88:91], v[32:35], v[72:75], v[88:91]
  ds_read_b64_tr_b16 v[18:19], v4 offset:512
  v_mfma_f32_16x16x32_bf16 v[92:95], v[32:35], v[76:79], v[92:95]
  v_mfma_f32_16x16x32_bf16 v[96:99], v[36:39], v[64:67], v[96:99]
  ds_read_b128 v[52:55], v3 offset:1024
  v_mfma_f32_16x16x32_bf16 v[100:103], v[36:39], v[68:71], v[100:103]
  ds_read_b128 v[56:59], v3 offset:2048
  v_mfma_f32_16x16x32_bf16 v[104:107], v[36:39], v[72:75], v[104:107]
  ds_read_b128 v[60:63], v3 offset:3072
  v_mfma_f32_16x16x32_bf16 v[108:111], v[36:39], v[76:79], v[108:111]
  v_mfma_f32_16x16x32_bf16 v[112:115], v[40:43], v[64:67], v[112:115]
  ds_read_b64_tr_b16 v[20:21], v5 offset:0
  v_mfma_f32_16x16x32_bf16 v[116:119], v[40:43], v[68:71], v[116:119]
  ds_read_b64_tr_b16 v[22:23], v5 offset:512
  v_mfma_f32_16x16x32_bf16 v[120:123], v[40:43], v[72:75], v[120:123]
  ds_read_b64_tr_b16 v[24:25], v6 offset:0
  v_mfma_f32_16x16x32_bf16 v[124:127], v[40:43], v[76:79], v[124:127]
  v_mfma_f32_16x16x32_bf16 v[128:131], v[44:47], v[64:67], v[128:131]
  ds_read_b64_tr_b16 v[26:27], v6 offset:512
  v_mfma_f32_16x16x32_bf16 v[132:135], v[44:47], v[68:71], v[132:135]
  ds_read_b64_tr_b16 v[28:29], v7 offset:0
  v_mfma_f32_16x16x32_bf16 v[136:139], v[44:47], v[72:75], v[136:139]
  ds_read_b64_tr_b16 v[30:31], v7 offset:512
  v_mfma_f32_16x16x32_bf16 v[140:143], v[44:47], v[76:79], v[140:143]
  s_waitcnt vmcnt(0) lgkmcnt(0)
  s_barrier
  v_mfma_f32_16x16x32_bf16 v[80:83], v[16:19], v[48:51], v[80:83]
  ds_read_b128 v[64:67], v3 offset:8192
  v_mfma_f32_16x16x32_bf16 v[84:87], v[16:19], v[52:55], v[84:87]
  ds_read_b64_tr_b16 v[32:33], v4 offset:8192
  v_mfma_f32_16x16x32_bf16 v[88:91], v[16:19], v[56:59], v[88:91]
  ds_read_b64_tr_b16 v[34:35], v4 offset:8704
  v_mfma_f32_16x16x32_bf16 v[92:95], v[16:19], v[60:63], v[92:95]
  v_mfma_f32_16x16x32_bf16 v[96:99], v[20:23], v[48:51], v[96:99]
  ds_read_b128 v[68:71], v3 offset:9216
  v_mfma_f32_16x16x32_bf16 v[100:103], v[20:23], v[52:55], v[100:103]
  ds_read_b128 v[72:75], v3 offset:10240
  v_mfma_f32_16x16x32_bf16 v[104:107], v[20:23], v[56:59], v[104:107]
  ds_read_b128 v[76:79], v3 offset:11264
  v_mfma_f32_16x16x32_bf16 v[108:111], v[20:23], v[60:63], v[108:111]
  v_mfma_f32_16x16x32_bf16 v[112:115], v[24:27], v[48:51], v[112:115]
  ds_read_b64_tr_b16 v[36:37], v5 offset:8192
  v_mfma_f32_16x16x32_bf16 v[116:119], v[24:27], v[52:55], v[116:119]
  ds_read_b64_tr_b16 v[38:39], v5 offset:8704
  v_mfma_f32_16x16x32_bf16 v[120:123], v[24:27], v[56:59], v[120:123]
  ds_read_b64_tr_b16 v[40:41], v6 offset:8192
  v_mfma_f32_16x16x32_bf16 v[124:127], v[24:27], v[60:63], v[124:127]
  v_mfma_f32_16x16x32_bf16 v[128:131], v[28:31], v[48:51], v[128:131]
  ds_read_b64_tr_b16 v[42:43], v6 offset:8704
  v_mfma_f32_16x16x32_bf16 v[132:135], v[28:31], v[52:55], v[132:135]
  ds_read_b64_tr_b16 v[44:45], v7 offset:8192
  v_mfma_f32_16x16x32_bf16 v[136:139], v[28:31], v[56:59], v[136:139]
  ds_read_b64_tr_b16 v[46:47], v7 offset:8704
  v_mfma_f32_16x16x32_bf16 v[140:143], v[28:31], v[60:63], v[140:143]
  s_waitcnt lgkmcnt(0)
  v_mfma_f32_16x16x32_bf16 v[80:83], v[32:35], v[64:67], v[80:83]
  v_mfma_f32_16x16x32_bf16 v[84:87], v[32:35], v[68:71], v[84:87]
  v_mfma_f32_16x16x32_bf16 v[88:91], v[32:35], v[72:75], v[88:91]
  v_mfma_f32_16x16x32_bf16 v[92:95], v[32:35], v[76:79], v[92:95]
  v_mfma_f32_16x16x32_bf16 v[96:99], v[36:39], v[64:67], v[96:99]
  v_mfma_f32_16x16x32_bf16 v[100:103], v[36:39], v[68:71], v[100:103]
  v_mfma_f32_16x16x32_bf16 v[104:107], v[36:39], v[72:75], v[104:107]
  v_mfma_f32_16x16x32_bf16 v[108:111], v[36:39], v[76:79], v[108:111]
  v_mfma_f32_16x16x32_bf16 v[112:115], v[40:43], v[64:67], v[112:115]
  v_mfma_f32_16x16x32_bf16 v[116:119], v[40:43], v[68:71], v[116:119]
  v_mfma_f32_16x16x32_bf16 v[120:123], v[40:43], v[72:75], v[120:123]
  v_mfma_f32_16x16x32_bf16 v[124:127], v[40:43], v[76:79], v[124:127]
  v_mfma_f32_16x16x32_bf16 v[128:131], v[44:47], v[64:67], v[128:131]
  v_mfma_f32_16x16x32_bf16 v[132:135], v[44:47], v[68:71], v[132:135]
  v_mfma_f32_16x16x32_bf16 v[136:139], v[44:47], v[72:75], v[136:139]
  v_mfma_f32_16x16x32_bf16 v[140:143], v[44:47], v[76:79], v[140:143]
  s_nop 15
  s_nop 3
  v_and_b32 v8, 15, v0
  v_bfe_u32 v10, v0, 4, 1
  v_lshlrev_b32 v10, 5, v10
  v_lshrrev_b32 v9, 5, v0
  v_lshl_add_u32 v10, v9, 4, v10
  s_lshl_b32 s96, s55, 6
  v_add_u32 v12, s96, v8
  v_lshl_add_u32 v10, v12, 6, v10
  s_lshl_b32 s96, s54, 18
  v_add_u32 v10, s96, v10
  s_lshl_b32 s96, s69, 6
  s_lshl_b32 s97, s70, 12
  s_add_u32 s96, s96, s97
  s_lshl_b32 s97, s71, 22
  s_add_u32 s96, s96, s97
  s_add_u32 s96, s96, 0x2000000
  s_add_u32 s99, s96, 0x0
  s_add_u32 s98, s99, 0x20000
  v_cvt_pk_bf16_f32 v16, v80, v81
  v_cvt_pk_bf16_f32 v17, v82, v83
  v_cvt_pk_bf16_f32 v18, v96, v97
  v_cvt_pk_bf16_f32 v19, v98, v99
  s_nop 1
  v_permlane16_swap_b32 v16, v18
  v_permlane16_swap_b32 v17, v19
  buffer_store_dwordx4 v[16:19], v10, s[44:47], s99 offen offset:0 sc1
  v_cvt_pk_bf16_f32 v20, v112, v113
  v_cvt_pk_bf16_f32 v21, v114, v115
  v_cvt_pk_bf16_f32 v22, v128, v129
  v_cvt_pk_bf16_f32 v23, v130, v131
  s_nop 1
  v_permlane16_swap_b32 v20, v22
  v_permlane16_swap_b32 v21, v23
  buffer_store_dwordx4 v[20:23], v10, s[44:47], s98 offen offset:0 sc1
  s_add_u32 s99, s96, 0x400
  s_add_u32 s98, s99, 0x20000
  v_cvt_pk_bf16_f32 v24, v84, v85
  v_cvt_pk_bf16_f32 v25, v86, v87
  v_cvt_pk_bf16_f32 v26, v100, v101
  v_cvt_pk_bf16_f32 v27, v102, v103
  s_nop 1
  v_permlane16_swap_b32 v24, v26
  v_permlane16_swap_b32 v25, v27
  buffer_store_dwordx4 v[24:27], v10, s[44:47], s99 offen offset:0 sc1
  v_cvt_pk_bf16_f32 v28, v116, v117
  v_cvt_pk_bf16_f32 v29, v118, v119
  v_cvt_pk_bf16_f32 v30, v132, v133
  v_cvt_pk_bf16_f32 v31, v134, v135
  s_nop 1
  v_permlane16_swap_b32 v28, v30
  v_permlane16_swap_b32 v29, v31
  buffer_store_dwordx4 v[28:31], v10, s[44:47], s98 offen offset:0 sc1
  s_add_u32 s99, s96, 0x800
  s_add_u32 s98, s99, 0x20000
  v_cvt_pk_bf16_f32 v16, v88, v89
  v_cvt_pk_bf16_f32 v17, v90, v91
  v_cvt_pk_bf16_f32 v18, v104, v105
  v_cvt_pk_bf16_f32 v19, v106, v107
  s_nop 1
  v_permlane16_swap_b32 v16, v18
  v_permlane16_swap_b32 v17, v19
  buffer_store_dwordx4 v[16:19], v10, s[44:47], s99 offen offset:0 sc1
  v_cvt_pk_bf16_f32 v20, v120, v121
  v_cvt_pk_bf16_f32 v21, v122, v123
  v_cvt_pk_bf16_f32 v22, v136, v137
  v_cvt_pk_bf16_f32 v23, v138, v139
  s_nop 1
  v_permlane16_swap_b32 v20, v22
  v_permlane16_swap_b32 v21, v23
  buffer_store_dwordx4 v[20:23], v10, s[44:47], s98 offen offset:0 sc1
  s_add_u32 s99, s96, 0xc00
  s_add_u32 s98, s99, 0x20000
  v_cvt_pk_bf16_f32 v24, v92, v93
  v_cvt_pk_bf16_f32 v25, v94, v95
  v_cvt_pk_bf16_f32 v26, v108, v109
  v_cvt_pk_bf16_f32 v27, v110, v111
  s_nop 1
  v_permlane16_swap_b32 v24, v26
  v_permlane16_swap_b32 v25, v27
  buffer_store_dwordx4 v[24:27], v10, s[44:47], s99 offen offset:0 sc1
  v_cvt_pk_bf16_f32 v28, v124, v125
  v_cvt_pk_bf16_f32 v29, v126, v127
  v_cvt_pk_bf16_f32 v30, v140, v141
  v_cvt_pk_bf16_f32 v31, v142, v143
  s_nop 1
  v_permlane16_swap_b32 v28, v30
  v_permlane16_swap_b32 v29, v31
  buffer_store_dwordx4 v[28:31], v10, s[44:47], s98 offen offset:0 sc1
  s_lshr_b32 s72, s69, 7
L_mid_end:
  s_endpgm
.globl wo_kernel
.p2align 8
.type wo_kernel,@function
wo_kernel:
  s_cmp_ge_u32 s2, 256
  s_cbranch_scc1 L_wo_end
  s_load_dwordx16 s[4:19], s[0:1], 0
  s_load_dwordx4 s[20:23], s[0:1], 64
  s_load_dwordx2 s[24:25], s[0:1], 80
  v_lshrrev_b32 v1, 6, v0
  v_and_b32 v0, 63, v0
  s_nop 0
  v_readfirstlane_b32 s52, v1
  s_nop 3
  s_lshl_b32 s53, s52, 10
  s_waitcnt lgkmcnt(0)
  s_mov_b32 s44, s24
  s_mov_b32 s45, s25
  s_mov_b32 s46, 0x10000000
  s_mov_b32 s47, 0x00020000
  s_and_b32 s54, s52, 1
  s_lshr_b32 s55, s52, 1
  s_bfe_u32 s72, s2, 0x20001
  s_lshl_b32 s72, s72, 3
  s_bfe_u32 s73, s2, 0x30003
  s_add_u32 s72, s72, s73
  s_lshl_b32 s69, s72, 6
  s_and_b32 s72, s2, 1
  s_lshl_b32 s72, s72, 2
  s_lshr_b32 s73, s2, 6
  s_add_u32 s72, s72, s73
  s_lshl_b32 s70, s72, 7
  s_add_u32 s28, s24, 0x1c00000
  s_addc_u32 s29, s25, 0
  s_mov_b32 s30, 0x400000
  s_mov_b32 s31, 0x00020000
  s_mov_b32 s32, s8
  s_mov_b32 s33, s9
  s_mov_b32 s34, 0x200000
  s_mov_b32 s35, 0x00020000
  s_mov_b32 s48, s20
  s_mov_b32 s49, s21
  s_mov_b32 s50, 0x400000
  s_mov_b32 s51, 0x00020000
  s_mov_b32 s78, 0
  s_mov_b32 s79, 0
  v_and_b32 v8, 15, v0
  v_bfe_u32 v130, v0, 4, 1
  v_lshlrev_b32 v130, 5, v130
  v_lshrrev_b32 v9, 5, v0
  v_lshl_add_u32 v130, v9, 4, v130
  s_lshl_b32 s96, s55, 5
  v_add_u32 v131, s96, v8
  v_lshl_add_u32 v132, v131, 6, v130
  s_lshl_b32 s96, s54, 18
  v_add_u32 v132, s96, v132
  v_lshl_add_u32 v130, v131, 11, v130
  s_lshl_b32 s96, s54, 7
  v_add_u32 v130, s96, v130
  s_lshl_b32 s96, s69, 11
  s_lshl_b32 s97, s70, 1
  s_add_u32 s96, s96, s97
  s_lshl_b32 s98, s69, 6
  s_lshl_b32 s99, s70, 12
  s_add_u32 s98, s98, s99
  s_add_u32 s97, s98, 0x2000000
  buffer_load_dwordx4 v[96:99], v132, s[44:47], s97 offen
  s_add_u32 s97, s98, 0x2020000
  buffer_load_dwordx4 v[100:103], v132, s[44:47], s97 offen
  s_add_u32 s97, s98, 0x2000400
  buffer_load_dwordx4 v[104:107], v132, s[44:47], s97 offen
  s_add_u32 s97, s98, 0x2020400
  buffer_load_dwordx4 v[108:111], v132, s[44:47], s97 offen
  s_add_u32 s97, s98, 0x2400000
  buffer_load_dwordx4 v[112:115], v132, s[44:47], s97 offen
  s_add_u32 s97, s98, 0x2420000
  buffer_load_dwordx4 v[116:119], v132, s[44:47], s97 offen
  s_add_u32 s97, s98, 0x2400400
  buffer_load_dwordx4 v[120:123], v132, s[44:47], s97 offen
  s_add_u32 s97, s98, 0x2420400
  buffer_load_dwordx4 v[124:127], v132, s[44:47], s97 offen
  v_lshlrev_b32 v131, 2, v131
  s_lshl_b32 s100, s69, 2
  s_add_u32 s100, s100, 0x3000000
  buffer_load_dword v128, v131, s[44:47], s100 offen offset:0
  buffer_load_dword v129, v131, s[44:47], s100 offen offset:64
  s_mov_b32 s59, s96
  s_mov_b32 s64, 2048
  s_add_u32 s73, s52, 0
  s_lshr_b32 s74, s73, 2
  s_and_b32 s73, s73, 3
  s_lshl_b32 s73, s73, 3
  s_sub_u32 s73, s73, 32
  s_mul_i32 s73, s73, 2048
  s_lshl_b32 s74, s74, 7
  s_add_u32 s73, s73, s74
  s_lshl_b32 s74, s70, 1
  s_add_u32 s73, s73, s74
  s_add_u32 s60, s73, s78
  s_add_u32 s73, s52, 4
  s_lshr_b32 s74, s73, 2
  s_and_b32 s73, s73, 3
  s_lshl_b32 s73, s73, 3
  s_sub_u32 s73, s73, 32
  s_mul_i32 s73, s73, 2048
  s_lshl_b32 s74, s74, 7
  s_add_u32 s73, s73, s74
  s_lshl_b32 s74, s70, 1
  s_add_u32 s73, s73, s74
  s_add_u32 s61, s73, s78
  v_lshrrev_b32 v8, 3, v0
  v_bfe_u32 v9, v0, 4, 1
  s_and_b32 s77, s52, 1
  s_lshl_b32 s77, s77, 1
  v_or_b32 v9, s77, v9
  v_lshlrev_b32 v9, 1, v9
  v_xor_b32 v9, v0, v9
  v_and_b32 v9, 7, v9
  v_lshlrev_b32 v9, 4, v9
  v_mul_lo_u32 v2, v8, s64
  v_add_u32 v2, v2, v9
  s_lshl_b32 s64, s64, 5
  s_mul_i32 s72, s69, 64
  s_add_u32 s72, s72, s79
  v_lshrrev_b32 v8, 2, v0
  s_mov_b32 s77, 64
  v_mul_lo_u32 v1, v8, s77
  v_lshrrev_b32 v9, 4, v0
  v_sub_u32 v9, 0, v9
  v_xor_b32 v10, v0, v9
  v_and_b32 v10, 3, v10
  v_lshl_add_u32 v1, v10, 4, v1
  s_add_u32 s78, s52, 0
  s_mul_i32 s78, s78, 1024
  s_add_u32 s56, s78, s72
  s_sub_u32 s56, s56, 0x20000
  v_and_b32 v8, 15, v0
  v_lshrrev_b32 v9, 4, v0
  v_lshrrev_b32 v10, 2, v8
  v_sub_u32 v11, 0, v10
  v_xor_b32 v11, v11, v9
  v_and_b32 v11, 3, v11
  s_mul_i32 s77, s55, 2048
  v_lshlrev_b32 v12, 6, v8
  v_add_u32 v12, s77, v12
  v_lshl_add_u32 v3, v11, 4, v12
  v_bfe_u32 v8, v0, 2, 2
  v_lshl_add_u32 v10, v9, 3, v8
  v_lshlrev_b32 v10, 7, v10
  v_and_b32 v11, 3, v0
  v_lshl_add_u32 v10, v11, 3, v10
  v_add_u32 v10, 0x6000, v10
  v_bfe_u32 v11, v0, 3, 1
  v_bfe_u32 v12, v0, 4, 1
  v_lshl_or_b32 v11, v12, 1, v11
  s_mul_i32 s77, s54, 4096
  v_xor_b32 v12, 0, v11
  v_lshl_add_u32 v12, v12, 5, v10
  v_add_u32 v4, s77, v12
  v_xor_b32 v12, 1, v11
  v_lshl_add_u32 v12, v12, 5, v10
  v_add_u32 v5, s77, v12
  v_xor_b32 v12, 2, v11
  v_lshl_add_u32 v12, v12, 5, v10
  v_add_u32 v6, s77, v12
  v_xor_b32 v12, 3, v11
  v_lshl_add_u32 v12, v12, 5, v10
  v_add_u32 v7, s77, v12
  s_add_u32 m0, s53, 0x0
  s_add_u32 s56, s56, 0x20000
  buffer_load_dwordx4 v1, s[28:31], s56 offen lds
  s_add_u32 m0, s53, 0x6000
  s_add_u32 s60, s60, s64
  buffer_load_dwordx4 v2, s[32:35], s60 offen lds
  s_add_u32 m0, s53, 0x7000
  s_add_u32 s61, s61, s64
  buffer_load_dwordx4 v2, s[32:35], s61 offen lds
  s_add_u32 m0, s53, 0x1000
  s_add_u32 s56, s56, 0x20000
  buffer_load_dwordx4 v1, s[28:31], s56 offen lds
  s_add_u32 m0, s53, 0x8000
  s_add_u32 s60, s60, s64
  buffer_load_dwordx4 v2, s[32:35], s60 offen lds
  s_add_u32 m0, s53, 0x9000
  s_add_u32 s61, s61, s64
  buffer_load_dwordx4 v2, s[32:35], s61 offen lds
  s_add_u32 m0, s53, 0x2000
  s_add_u32 s56, s56, 0x20000
  buffer_load_dwordx4 v1, s[28:31], s56 offen lds
  s_add_u32 m0, s53, 0xa000
  s_add_u32 s60, s60, s64
  buffer_load_dwordx4 v2, s[32:35], s60 offen lds
  s_add_u32 m0, s53, 0xb000
  s_add_u32 s61, s61, s64
  buffer_load_dwordx4 v2, s[32:35], s61 offen lds
  s_add_u32 m0, s53, 0x3000
  s_add_u32 s56, s56, 0x20000
  buffer_load_dwordx4 v1, s[28:31], s56 offen lds
  s_add_u32 m0, s53, 0xc000
  s_add_u32 s60, s60, s64
  buffer_load_dwordx4 v2, s[32:35], s60 offen lds
  s_add_u32 m0, s53, 0xd000
  s_add_u32 s61, s61, s64
  buffer_load_dwordx4 v2, s[32:35], s61 offen lds
  s_add_u32 m0, s53, 0x4000
  s_add_u32 s56, s56, 0x20000
  buffer_load_dwordx4 v1, s[28:31], s56 offen lds
  s_add_u32 m0, s53, 0xe000
  s_add_u32 s60, s60, s64
  buffer_load_dwordx4 v2, s[32:35], s60 offen lds
  s_add_u32 m0, s53, 0xf000
  s_add_u32 s61, s61, s64
  buffer_load_dwordx4 v2, s[32:35], s61 offen lds
  s_add_u32 m0, s53, 0x5000
  s_add_u32 s56, s56, 0x20000
  buffer_load_dwordx4 v1, s[28:31], s56 offen lds
  s_add_u32 m0, s53, 0x10000
  s_add_u32 s60, s60, s64
  buffer_load_dwordx4 v2, s[32:35], s60 offen lds
  s_add_u32 m0, s53, 0x11000
  s_add_u32 s61, s61, s64
  buffer_load_dwordx4 v2, s[32:35], s61 offen lds
  v_mov_b32 v64, 0
  v_mov_b32 v65, 0
  v_mov_b32 v66, 0
  v_mov_b32 v67, 0
  v_mov_b32 v68, 0
  v_mov_b32 v69, 0
  v_mov_b32 v70, 0
  v_mov_b32 v71, 0
  v_mov_b32 v72, 0
  v_mov_b32 v73, 0
  v_mov_b32 v74, 0
  v_mov_b32 v75, 0
  v_mov_b32 v76, 0
  v_mov_b32 v77, 0
  v_mov_b32 v78, 0
  v_mov_b32 v79, 0
  v_mov_b32 v80, 0
  v_mov_b32 v81, 0
  v_mov_b32 v82, 0
  v_mov_b32 v83, 0
  v_mov_b32 v84, 0
  v_mov_b32 v85, 0
  v_mov_b32 v86, 0
  v_mov_b32 v87, 0
  v_mov_b32 v88, 0
  v_mov_b32 v89, 0
  v_mov_b32 v90, 0
  v_mov_b32 v91, 0
  v_mov_b32 v92, 0
  v_mov_b32 v93, 0
  v_mov_b32 v94, 0
  v_mov_b32 v95, 0
  s_waitcnt vmcnt(15)
  s_barrier
  ds_read_b128 v[48:51], v3 offset:0
  ds_read_b128 v[52:55], v3 offset:1024
  ds_read_b64_tr_b16 v[16:17], v4 offset:0
  ds_read_b64_tr_b16 v[18:19], v4 offset:512
  ds_read_b64_tr_b16 v[20:21], v5 offset:0
  ds_read_b64_tr_b16 v[22:23], v5 offset:512
  ds_read_b64_tr_b16 v[24:25], v6 offset:0
  ds_read_b64_tr_b16 v[26:27], v6 offset:512
  ds_read_b64_tr_b16 v[28:29], v7 offset:0
  ds_read_b64_tr_b16 v[30:31], v7 offset:512
  s_mov_b32 s68, 4
L_wo_loop:
  s_waitcnt vmcnt(12) lgkmcnt(0)
  s_barrier
  v_mfma_f32_16x16x32_bf16 v[64:67], v[16:19], v[48:51], v[64:67]
  ds_read_b128 v[56:59], v3 offset:4096
  ds_read_b64_tr_b16 v[32:33], v4 offset:8192
  ds_read_b64_tr_b16 v[34:35], v4 offset:8704
  v_mfma_f32_16x16x32_bf16 v[68:71], v[16:19], v[52:55], v[68:71]
  ds_read_b128 v[60:63], v3 offset:5120
  ds_read_b64_tr_b16 v[36:37], v5 offset:8192
  v_mfma_f32_16x16x32_bf16 v[72:75], v[20:23], v[48:51], v[72:75]
  ds_read_b64_tr_b16 v[38:39], v5 offset:8704
  ds_read_b64_tr_b16 v[40:41], v6 offset:8192
  ds_read_b64_tr_b16 v[42:43], v6 offset:8704
  v_mfma_f32_16x16x32_bf16 v[76:79], v[20:23], v[52:55], v[76:79]
  ds_read_b64_tr_b16 v[44:45], v7 offset:8192
  ds_read_b64_tr_b16 v[46:47], v7 offset:8704
  v_mfma_f32_16x16x32_bf16 v[80:83], v[24:27], v[48:51], v[80:83]
  s_add_u32 m0, s53, 0x0
  s_add_u32 s56, s56, 0x20000
  v_mfma_f32_16x16x32_bf16 v[84:87], v[24:27], v[52:55], v[84:87]
  buffer_load_dwordx4 v1, s[28:31], s56 offen lds
  s_add_u32 m0, s53, 0x6000
  s_add_u32 s60, s60, s64
  v_mfma_f32_16x16x32_bf16 v[88:91], v[28:31], v[48:51], v[88:91]
  buffer_load_dwordx4 v2, s[32:35], s60 offen lds
  s_add_u32 m0, s53, 0x7000
  v_mfma_f32_16x16x32_bf16 v[92:95], v[28:31], v[52:55], v[92:95]
  s_add_u32 s61, s61, s64
  buffer_load_dwordx4 v2, s[32:35], s61 offen lds
  s_waitcnt vmcnt(12) lgkmcnt(0)
  s_barrier
  v_mfma_f32_16x16x32_bf16 v[64:67], v[32:35], v[56:59], v[64:67]
  ds_read_b128 v[48:51], v3 offset:8192
  ds_read_b64_tr_b16 v[16:17], v4 offset:16384
  ds_read_b64_tr_b16 v[18:19], v4 offset:16896
  v_mfma_f32_16x16x32_bf16 v[68:71], v[32:35], v[60:63], v[68:71]
  ds_read_b128 v[52:55], v3 offset:9216
  ds_read_b64_tr_b16 v[20:21], v5 offset:16384
  v_mfma_f32_16x16x32_bf16 v[72:75], v[36:39], v[56:59], v[72:75]
  ds_read_b64_tr_b16 v[22:23], v5 offset:16896
  ds_read_b64_tr_b16 v[24:25], v6 offset:16384
  ds_read_b64_tr_b16 v[26:27], v6 offset:16896
  v_mfma_f32_16x16x32_bf16 v[76:79], v[36:39], v[60:63], v[76:79]
  ds_read_b64_tr_b16 v[28:29], v7 offset:16384
  ds_read_b64_tr_b16 v[30:31], v7 offset:16896
  v_mfma_f32_16x16x32_bf16 v[80:83], v[40:43], v[56:59], v[80:83]
  s_add_u32 m0, s53, 0x1000
  s_add_u32 s56, s56, 0x20000
  v_mfma_f32_16x16x32_bf16 v[84:87], v[40:43], v[60:63], v[84:87]
  buffer_load_dwordx4 v1, s[28:31], s56 offen lds
  s_add_u32 m0, s53, 0x8000
  s_add_u32 s60, s60, s64
  v_mfma_f32_16x16x32_bf16 v[88:91], v[44:47], v[56:59], v[88:91]
  buffer_load_dwordx4 v2, s[32:35], s60 offen lds
  s_add_u32 m0, s53, 0x9000
  v_mfma_f32_16x16x32_bf16 v[92:95], v[44:47], v[60:63], v[92:95]
  s_add_u32 s61, s61, s64
  buffer_load_dwordx4 v2, s[32:35], s61 offen lds
  s_waitcnt vmcnt(12) lgkmcnt(0)
  s_barrier
  v_mfma_f32_16x16x32_bf16 v[64:67], v[16:19], v[48:51], v[64:67]
  ds_read_b128 v[56:59], v3 offset:12288
  ds_read_b64_tr_b16 v[32:33], v4 offset:24576
  ds_read_b64_tr_b16 v[34:35], v4 offset:25088
  v_mfma_f32_16x16x32_bf16 v[68:71], v[16:19], v[52:55], v[68:71]
  ds_read_b128 v[60:63], v3 offset:13312
  ds_read_b64_tr_b16 v[36:37], v5 offset:24576
  v_mfma_f32_16x16x32_bf16 v[72:75], v[20:23], v[48:51], v[72:75]
  ds_read_b64_tr_b16 v[38:39], v5 offset:25088
  ds_read_b64_tr_b16 v[40:41], v6 offset:24576
  ds_read_b64_tr_b16 v[42:43], v6 offset:25088
  v_mfma_f32_16x16x32_bf16 v[76:79], v[20:23], v[52:55], v[76:79]
  ds_read_b64_tr_b16 v[44:45], v7 offset:24576
  ds_read_b64_tr_b16 v[46:47], v7 offset:25088
  v_mfma_f32_16x16x32_bf16 v[80:83], v[24:27], v[48:51], v[80:83]
  s_add_u32 m0, s53, 0x2000
  s_add_u32 s56, s56, 0x20000
  v_mfma_f32_16x16x32_bf16 v[84:87], v[24:27], v[52:55], v[84:87]
  buffer_load_dwordx4 v1, s[28:31], s56 offen lds
  s_add_u32 m0, s53, 0xa000
  s_add_u32 s60, s60, s64
  v_mfma_f32_16x16x32_bf16 v[88:91], v[28:31], v[48:51], v[88:91]
  buffer_load_dwordx4 v2, s[32:35], s60 offen lds
  s_add_u32 m0, s53, 0xb000
  v_mfma_f32_16x16x32_bf16 v[92:95], v[28:31], v[52:55], v[92:95]
  s_add_u32 s61, s61, s64
  buffer_load_dwordx4 v2, s[32:35], s61 offen lds
  s_waitcnt vmcnt(12) lgkmcnt(0)
  s_barrier
  v_mfma_f32_16x16x32_bf16 v[64:67], v[32:35], v[56:59], v[64:67]
  ds_read_b128 v[48:51], v3 offset:16384
  ds_read_b64_tr_b16 v[16:17], v4 offset:32768
  ds_read_b64_tr_b16 v[18:19], v4 offset:33280
  v_mfma_f32_16x16x32_bf16 v[68:71], v[32:35], v[60:63], v[68:71]
  ds_read_b128 v[52:55], v3 offset:17408
  ds_read_b64_tr_b16 v[20:21], v5 offset:32768
  v_mfma_f32_16x16x32_bf16 v[72:75], v[36:39], v[56:59], v[72:75]
  ds_read_b64_tr_b16 v[22:23], v5 offset:33280
  ds_read_b64_tr_b16 v[24:25], v6 offset:32768
  ds_read_b64_tr_b16 v[26:27], v6 offset:33280
  v_mfma_f32_16x16x32_bf16 v[76:79], v[36:39], v[60:63], v[76:79]
  ds_read_b64_tr_b16 v[28:29], v7 offset:32768
  ds_read_b64_tr_b16 v[30:31], v7 offset:33280
  v_mfma_f32_16x16x32_bf16 v[80:83], v[40:43], v[56:59], v[80:83]
  s_add_u32 m0, s53, 0x3000
  s_add_u32 s56, s56, 0x20000
  v_mfma_f32_16x16x32_bf16 v[84:87], v[40:43], v[60:63], v[84:87]
  buffer_load_dwordx4 v1, s[28:31], s56 offen lds
  s_add_u32 m0, s53, 0xc000
  s_add_u32 s60, s60, s64
  v_mfma_f32_16x16x32_bf16 v[88:91], v[44:47], v[56:59], v[88:91]
  buffer_load_dwordx4 v2, s[32:35], s60 offen lds
  s_add_u32 m0, s53, 0xd000
  v_mfma_f32_16x16x32_bf16 v[92:95], v[44:47], v[60:63], v[92:95]
  s_add_u32 s61, s61, s64
  buffer_load_dwordx4 v2, s[32:35], s61 offen lds
  s_waitcnt vmcnt(12) lgkmcnt(0)
  s_barrier
  v_mfma_f32_16x16x32_bf16 v[64:67], v[16:19], v[48:51], v[64:67]
  ds_read_b128 v[56:59], v3 offset:20480
  ds_read_b64_tr_b16 v[32:33], v4 offset:40960
  ds_read_b64_tr_b16 v[34:35], v4 offset:41472
  v_mfma_f32_16x16x32_bf16 v[68:71], v[16:19], v[52:55], v[68:71]
  ds_read_b128 v[60:63], v3 offset:21504
  ds_read_b64_tr_b16 v[36:37], v5 offset:40960
  v_mfma_f32_16x16x32_bf16 v[72:75], v[20:23], v[48:51], v[72:75]
  ds_read_b64_tr_b16 v[38:39], v5 offset:41472
  ds_read_b64_tr_b16 v[40:41], v6 offset:40960
  ds_read_b64_tr_b16 v[42:43], v6 offset:41472
  v_mfma_f32_16x16x32_bf16 v[76:79], v[20:23], v[52:55], v[76:79]
  ds_read_b64_tr_b16 v[44:45], v7 offset:40960
  ds_read_b64_tr_b16 v[46:47], v7 offset:41472
  v_mfma_f32_16x16x32_bf16 v[80:83], v[24:27], v[48:51], v[80:83]
  s_add_u32 m0, s53, 0x4000
  s_add_u32 s56, s56, 0x20000
  v_mfma_f32_16x16x32_bf16 v[84:87], v[24:27], v[52:55], v[84:87]
  buffer_load_dwordx4 v1, s[28:31], s56 offen lds
  s_add_u32 m0, s53, 0xe000
  s_add_u32 s60, s60, s64
  v_mfma_f32_16x16x32_bf16 v[88:91], v[28:31], v[48:51], v[88:91]
  buffer_load_dwordx4 v2, s[32:35], s60 offen lds
  s_add_u32 m0, s53, 0xf000
  v_mfma_f32_16x16x32_bf16 v[92:95], v[28:31], v[52:55], v[92:95]
  s_add_u32 s61, s61, s64
  buffer_load_dwordx4 v2, s[32:35], s61 offen lds
  s_waitcnt vmcnt(12) lgkmcnt(0)
  s_barrier
  v_mfma_f32_16x16x32_bf16 v[64:67], v[32:35], v[56:59], v[64:67]
  ds_read_b128 v[48:51], v3 offset:0
  ds_read_b64_tr_b16 v[16:17], v4 offset:0
  ds_read_b64_tr_b16 v[18:19], v4 offset:512
  v_mfma_f32_16x16x32_bf16 v[68:71], v[32:35], v[60:63], v[68:71]
  ds_read_b128 v[52:55], v3 offset:1024
  ds_read_b64_tr_b16 v[20:21], v5 offset:0
  v_mfma_f32_16x16x32_bf16 v[72:75], v[36:39], v[56:59], v[72:75]
  ds_read_b64_tr_b16 v[22:23], v5 offset:512
  ds_read_b64_tr_b16 v[24:25], v6 offset:0
  ds_read_b64_tr_b16 v[26:27], v6 offset:512
  v_mfma_f32_16x16x32_bf16 v[76:79], v[36:39], v[60:63], v[76:79]
  ds_read_b64_tr_b16 v[28:29], v7 offset:0
  ds_read_b64_tr_b16 v[30:31], v7 offset:512
  v_mfma_f32_16x16x32_bf16 v[80:83], v[40:43], v[56:59], v[80:83]
  s_add_u32 m0, s53, 0x5000
  s_add_u32 s56, s56, 0x20000
  v_mfma_f32_16x16x32_bf16 v[84:87], v[40:43], v[60:63], v[84:87]
  buffer_load_dwordx4 v1, s[28:31], s56 offen lds
  s_add_u32 m0, s53, 0x10000
  s_add_u32 s60, s60, s64
  v_mfma_f32_16x16x32_bf16 v[88:91], v[44:47], v[56:59], v[88:91]
  buffer_load_dwordx4 v2, s[32:35], s60 offen lds
  s_add_u32 m0, s53, 0x11000
  v_mfma_f32_16x16x32_bf16 v[92:95], v[44:47], v[60:63], v[92:95]
  s_add_u32 s61, s61, s64
  buffer_load_dwordx4 v2, s[32:35], s61 offen lds
  s_sub_u32 s68, s68, 1
  s_cmp_lg_u32 s68, 0
  s_cbranch_scc1 L_wo_loop
  s_waitcnt vmcnt(12) lgkmcnt(0)
  s_barrier
  v_mfma_f32_16x16x32_bf16 v[64:67], v[16:19], v[48:51], v[64:67]
  ds_read_b128 v[56:59], v3 offset:4096
  ds_read_b64_tr_b16 v[32:33], v4 offset:8192
  ds_read_b64_tr_b16 v[34:35], v4 offset:8704
  v_mfma_f32_16x16x32_bf16 v[68:71], v[16:19], v[52:55], v[68:71]
  ds_read_b128 v[60:63], v3 offset:5120
  ds_read_b64_tr_b16 v[36:37], v5 offset:8192
  v_mfma_f32_16x16x32_bf16 v[72:75], v[20:23], v[48:51], v[72:75]
  ds_read_b64_tr_b16 v[38:39], v5 offset:8704
  ds_read_b64_tr_b16 v[40:41], v6 offset:8192
  ds_read_b64_tr_b16 v[42:43], v6 offset:8704
  v_mfma_f32_16x16x32_bf16 v[76:79], v[20:23], v[52:55], v[76:79]
  ds_read_b64_tr_b16 v[44:45], v7 offset:8192
  ds_read_b64_tr_b16 v[46:47], v7 offset:8704
  v_mfma_f32_16x16x32_bf16 v[80:83], v[24:27], v[48:51], v[80:83]
  s_add_u32 m0, s53, 0x0
  s_add_u32 s56, s56, 0x20000
  v_mfma_f32_16x16x32_bf16 v[84:87], v[24:27], v[52:55], v[84:87]
  buffer_load_dwordx4 v1, s[28:31], s56 offen lds
  s_add_u32 m0, s53, 0x6000
  s_add_u32 s60, s60, s64
  v_mfma_f32_16x16x32_bf16 v[88:91], v[28:31], v[48:51], v[88:91]
  buffer_load_dwordx4 v2, s[32:35], s60 offen lds
  s_add_u32 m0, s53, 0x7000
  v_mfma_f32_16x16x32_bf16 v[92:95], v[28:31], v[52:55], v[92:95]
  s_add_u32 s61, s61, s64
  buffer_load_dwordx4 v2, s[32:35], s61 offen lds
  s_waitcnt vmcnt(12) lgkmcnt(0)
  s_barrier
  v_mfma_f32_16x16x32_bf16 v[64:67], v[32:35], v[56:59], v[64:67]
  ds_read_b128 v[48:51], v3 offset:8192
  ds_read_b64_tr_b16 v[16:17], v4 offset:16384
  ds_read_b64_tr_b16 v[18:19], v4 offset:16896
  v_mfma_f32_16x16x32_bf16 v[68:71], v[32:35], v[60:63], v[68:71]
  ds_read_b128 v[52:55], v3 offset:9216
  ds_read_b64_tr_b16 v[20:21], v5 offset:16384
  v_mfma_f32_16x16x32_bf16 v[72:75], v[36:39], v[56:59], v[72:75]
  ds_read_b64_tr_b16 v[22:23], v5 offset:16896
  ds_read_b64_tr_b16 v[24:25], v6 offset:16384
  ds_read_b64_tr_b16 v[26:27], v6 offset:16896
  v_mfma_f32_16x16x32_bf16 v[76:79], v[36:39], v[60:63], v[76:79]
  ds_read_b64_tr_b16 v[28:29], v7 offset:16384
  ds_read_b64_tr_b16 v[30:31], v7 offset:16896
  v_mfma_f32_16x16x32_bf16 v[80:83], v[40:43], v[56:59], v[80:83]
  s_add_u32 m0, s53, 0x1000
  s_add_u32 s56, s56, 0x20000
  v_mfma_f32_16x16x32_bf16 v[84:87], v[40:43], v[60:63], v[84:87]
  buffer_load_dwordx4 v1, s[28:31], s56 offen lds
  s_add_u32 m0, s53, 0x8000
  s_add_u32 s60, s60, s64
  v_mfma_f32_16x16x32_bf16 v[88:91], v[44:47], v[56:59], v[88:91]
  buffer_load_dwordx4 v2, s[32:35], s60 offen lds
  s_add_u32 m0, s53, 0x9000
  v_mfma_f32_16x16x32_bf16 v[92:95], v[44:47], v[60:63], v[92:95]
  s_add_u32 s61, s61, s64
  buffer_load_dwordx4 v2, s[32:35], s61 offen lds
  s_waitcnt vmcnt(12) lgkmcnt(0)
  s_barrier
  v_mfma_f32_16x16x32_bf16 v[64:67], v[16:19], v[48:51], v[64:67]
  ds_read_b128 v[56:59], v3 offset:12288
  ds_read_b64_tr_b16 v[32:33], v4 offset:24576
  v_mfma_f32_16x16x32_bf16 v[68:71], v[16:19], v[52:55], v[68:71]
  ds_read_b64_tr_b16 v[34:35], v4 offset:25088
  v_mfma_f32_16x16x32_bf16 v[72:75], v[20:23], v[48:51], v[72:75]
  ds_read_b128 v[60:63], v3 offset:13312
  v_mfma_f32_16x16x32_bf16 v[76:79], v[20:23], v[52:55], v[76:79]
  ds_read_b64_tr_b16 v[36:37], v5 offset:24576
  v_mfma_f32_16x16x32_bf16 v[80:83], v[24:27], v[48:51], v[80:83]
  ds_read_b64_tr_b16 v[38:39], v5 offset:25088
  ds_read_b64_tr_b16 v[40:41], v6 offset:24576
  v_mfma_f32_16x16x32_bf16 v[84:87], v[24:27], v[52:55], v[84:87]
  ds_read_b64_tr_b16 v[42:43], v6 offset:25088
  v_mfma_f32_16x16x32_bf16 v[88:91], v[28:31], v[48:51], v[88:91]
  ds_read_b64_tr_b16 v[44:45], v7 offset:24576
  v_mfma_f32_16x16x32_bf16 v[92:95], v[28:31], v[52:55], v[92:95]
  ds_read_b64_tr_b16 v[46:47], v7 offset:25088
  s_waitcnt vmcnt(9) lgkmcnt(0)
  s_barrier
  v_mfma_f32_16x16x32_bf16 v[64:67], v[32:35], v[56:59], v[64:67]
  ds_read_b128 v[48:51], v3 offset:16384
  ds_read_b64_tr_b16 v[16:17], v4 offset:32768
  v_mfma_f32_16x16x32_bf16 v[68:71], v[32:35], v[60:63], v[68:71]
  ds_read_b64_tr_b16 v[18:19], v4 offset:33280
  v_mfma_f32_16x16x32_bf16 v[72:75], v[36:39], v[56:59], v[72:75]
  ds_read_b128 v[52:55], v3 offset:17408
  v_mfma_f32_16x16x32_bf16 v[76:79], v[36:39], v[60:63], v[76:79]
  ds_read_b64_tr_b16 v[20:21], v5 offset:32768
  v_mfma_f32_16x16x32_bf16 v[80:83], v[40:43], v[56:59], v[80:83]
  ds_read_b64_tr_b16 v[22:23], v5 offset:33280
  ds_read_b64_tr_b16 v[24:25], v6 offset:32768
  v_mfma_f32_16x16x32_bf16 v[84:87], v[40:43], v[60:63], v[84:87]
  ds_read_b64_tr_b16 v[26:27], v6 offset:33280
  v_mfma_f32_16x16x32_bf16 v[88:91], v[44:47], v[56:59], v[88:91]
  ds_read_b64_tr_b16 v[28:29], v7 offset:32768
  v_mfma_f32_16x16x32_bf16 v[92:95], v[44:47], v[60:63], v[92:95]
  ds_read_b64_tr_b16 v[30:31], v7 offset:33280
  s_waitcnt vmcnt(6) lgkmcnt(0)
  s_barrier
  v_mfma_f32_16x16x32_bf16 v[64:67], v[16:19], v[48:51], v[64:67]
  ds_read_b128 v[56:59], v3 offset:20480
  ds_read_b64_tr_b16 v[32:33], v4 offset:40960
  v_mfma_f32_16x16x32_bf16 v[68:71], v[16:19], v[52:55], v[68:71]
  ds_read_b64_tr_b16 v[34:35], v4 offset:41472
  v_mfma_f32_16x16x32_bf16 v[72:75], v[20:23], v[48:51], v[72:75]
  ds_read_b128 v[60:63], v3 offset:21504
  v_mfma_f32_16x16x32_bf16 v[76:79], v[20:23], v[52:55], v[76:79]
  ds_read_b64_tr_b16 v[36:37], v5 offset:40960
  v_mfma_f32_16x16x32_bf16 v[80:83], v[24:27], v[48:51], v[80:83]
  ds_read_b64_tr_b16 v[38:39], v5 offset:41472
  ds_read_b64_tr_b16 v[40:41], v6 offset:40960
  v_mfma_f32_16x16x32_bf16 v[84:87], v[24:27], v[52:55], v[84:87]
  ds_read_b64_tr_b16 v[42:43], v6 offset:41472
  v_mfma_f32_16x16x32_bf16 v[88:91], v[28:31], v[48:51], v[88:91]
  ds_read_b64_tr_b16 v[44:45], v7 offset:40960
  v_mfma_f32_16x16x32_bf16 v[92:95], v[28:31], v[52:55], v[92:95]
  ds_read_b64_tr_b16 v[46:47], v7 offset:41472
  s_waitcnt vmcnt(3) lgkmcnt(0)
  s_barrier
  v_mfma_f32_16x16x32_bf16 v[64:67], v[32:35], v[56:59], v[64:67]
  ds_read_b128 v[48:51], v3 offset:0
  ds_read_b64_tr_b16 v[16:17], v4 offset:0
  v_mfma_f32_16x16x32_bf16 v[68:71], v[32:35], v[60:63], v[68:71]
  ds_read_b64_tr_b16 v[18:19], v4 offset:512
  v_mfma_f32_16x16x32_bf16 v[72:75], v[36:39], v[56:59], v[72:75]
  ds_read_b128 v[52:55], v3 offset:1024
  v_mfma_f32_16x16x32_bf16 v[76:79], v[36:39], v[60:63], v[76:79]
  ds_read_b64_tr_b16 v[20:21], v5 offset:0
  v_mfma_f32_16x16x32_bf16 v[80:83], v[40:43], v[56:59], v[80:83]
  ds_read_b64_tr_b16 v[22:23], v5 offset:512
  ds_read_b64_tr_b16 v[24:25], v6 offset:0
  v_mfma_f32_16x16x32_bf16 v[84:87], v[40:43], v[60:63], v[84:87]
  ds_read_b64_tr_b16 v[26:27], v6 offset:512
  v_mfma_f32_16x16x32_bf16 v[88:91], v[44:47], v[56:59], v[88:91]
  ds_read_b64_tr_b16 v[28:29], v7 offset:0
  v_mfma_f32_16x16x32_bf16 v[92:95], v[44:47], v[60:63], v[92:95]
  ds_read_b64_tr_b16 v[30:31], v7 offset:512
  s_waitcnt vmcnt(0) lgkmcnt(0)
  s_barrier
  v_mfma_f32_16x16x32_bf16 v[64:67], v[16:19], v[48:51], v[64:67]
  ds_read_b128 v[56:59], v3 offset:4096
  ds_read_b64_tr_b16 v[32:33], v4 offset:8192
  v_mfma_f32_16x16x32_bf16 v[68:71], v[16:19], v[52:55], v[68:71]
  ds_read_b64_tr_b16 v[34:35], v4 offset:8704
  v_mfma_f32_16x16x32_bf16 v[72:75], v[20:23], v[48:51], v[72:75]
  ds_read_b128 v[60:63], v3 offset:5120
  v_mfma_f32_16x16x32_bf16 v[76:79], v[20:23], v[52:55], v[76:79]
  ds_read_b64_tr_b16 v[36:37], v5 offset:8192
  v_mfma_f32_16x16x32_bf16 v[80:83], v[24:27], v[48:51], v[80:83]
  ds_read_b64_tr_b16 v[38:39], v5 offset:8704
  ds_read_b64_tr_b16 v[40:41], v6 offset:8192
  v_mfma_f32_16x16x32_bf16 v[84:87], v[24:27], v[52:55], v[84:87]
  ds_read_b64_tr_b16 v[42:43], v6 offset:8704
  v_mfma_f32_16x16x32_bf16 v[88:91], v[28:31], v[48:51], v[88:91]
  ds_read_b64_tr_b16 v[44:45], v7 offset:8192
  v_mfma_f32_16x16x32_bf16 v[92:95], v[28:31], v[52:55], v[92:95]
  ds_read_b64_tr_b16 v[46:47], v7 offset:8704
  s_waitcnt lgkmcnt(0)
  v_mfma_f32_16x16x32_bf16 v[64:67], v[32:35], v[56:59], v[64:67]
  v_mfma_f32_16x16x32_bf16 v[68:71], v[32:35], v[60:63], v[68:71]
  v_mfma_f32_16x16x32_bf16 v[72:75], v[36:39], v[56:59], v[72:75]
  v_mfma_f32_16x16x32_bf16 v[76:79], v[36:39], v[60:63], v[76:79]
  v_mfma_f32_16x16x32_bf16 v[80:83], v[40:43], v[56:59], v[80:83]
  v_mfma_f32_16x16x32_bf16 v[84:87], v[40:43], v[60:63], v[84:87]
  v_mfma_f32_16x16x32_bf16 v[88:91], v[44:47], v[56:59], v[88:91]
  v_mfma_f32_16x16x32_bf16 v[92:95], v[44:47], v[60:63], v[92:95]
  s_nop 15
  s_nop 3
  s_waitcnt vmcnt(0)
  s_add_u32 s99, s59, 0x0
  v_permlane16_swap_b32 v96, v98
  v_permlane16_swap_b32 v97, v99
  v_permlane16_swap_b32 v112, v114
  v_permlane16_swap_b32 v113, v115
  v_lshlrev_b32 v8, 16, v96
  v_lshlrev_b32 v9, 16, v112
  v_add_f32 v8, v8, v9
  v_sub_f32 v64, v64, v8
  v_fma_f32 v64, v64, v128, v8
  v_and_b32 v8, 0xffff0000, v96
  v_and_b32 v9, 0xffff0000, v112
  v_add_f32 v8, v8, v9
  v_sub_f32 v65, v65, v8
  v_fma_f32 v65, v65, v128, v8
  v_lshlrev_b32 v8, 16, v97
  v_lshlrev_b32 v9, 16, v113
  v_add_f32 v8, v8, v9
  v_sub_f32 v66, v66, v8
  v_fma_f32 v66, v66, v128, v8
  v_and_b32 v8, 0xffff0000, v97
  v_and_b32 v9, 0xffff0000, v113
  v_add_f32 v8, v8, v9
  v_sub_f32 v67, v67, v8
  v_fma_f32 v67, v67, v128, v8
  v_lshlrev_b32 v8, 16, v98
  v_lshlrev_b32 v9, 16, v114
  v_add_f32 v8, v8, v9
  v_sub_f32 v72, v72, v8
  v_fma_f32 v72, v72, v128, v8
  v_and_b32 v8, 0xffff0000, v98
  v_and_b32 v9, 0xffff0000, v114
  v_add_f32 v8, v8, v9
  v_sub_f32 v73, v73, v8
  v_fma_f32 v73, v73, v128, v8
  v_lshlrev_b32 v8, 16, v99
  v_lshlrev_b32 v9, 16, v115
  v_add_f32 v8, v8, v9
  v_sub_f32 v74, v74, v8
  v_fma_f32 v74, v74, v128, v8
  v_and_b32 v8, 0xffff0000, v99
  v_and_b32 v9, 0xffff0000, v115
  v_add_f32 v8, v8, v9
  v_sub_f32 v75, v75, v8
  v_fma_f32 v75, v75, v128, v8
  v_cvt_pk_bf16_f32 v96, v64, v65
  v_cvt_pk_bf16_f32 v97, v66, v67
  v_cvt_pk_bf16_f32 v98, v72, v73
  v_cvt_pk_bf16_f32 v99, v74, v75
  s_nop 1
  v_permlane16_swap_b32 v96, v98
  v_permlane16_swap_b32 v97, v99
  buffer_store_dwordx4 v[96:99], v130, s[48:51], s99 offen offset:0
  v_permlane16_swap_b32 v100, v102
  v_permlane16_swap_b32 v101, v103
  v_permlane16_swap_b32 v116, v118
  v_permlane16_swap_b32 v117, v119
  v_lshlrev_b32 v8, 16, v100
  v_lshlrev_b32 v9, 16, v116
  v_add_f32 v8, v8, v9
  v_sub_f32 v80, v80, v8
  v_fma_f32 v80, v80, v128, v8
  v_and_b32 v8, 0xffff0000, v100
  v_and_b32 v9, 0xffff0000, v116
  v_add_f32 v8, v8, v9
  v_sub_f32 v81, v81, v8
  v_fma_f32 v81, v81, v128, v8
  v_lshlrev_b32 v8, 16, v101
  v_lshlrev_b32 v9, 16, v117
  v_add_f32 v8, v8, v9
  v_sub_f32 v82, v82, v8
  v_fma_f32 v82, v82, v128, v8
  v_and_b32 v8, 0xffff0000, v101
  v_and_b32 v9, 0xffff0000, v117
  v_add_f32 v8, v8, v9
  v_sub_f32 v83, v83, v8
  v_fma_f32 v83, v83, v128, v8
  v_lshlrev_b32 v8, 16, v102
  v_lshlrev_b32 v9, 16, v118
  v_add_f32 v8, v8, v9
  v_sub_f32 v88, v88, v8
  v_fma_f32 v88, v88, v128, v8
  v_and_b32 v8, 0xffff0000, v102
  v_and_b32 v9, 0xffff0000, v118
  v_add_f32 v8, v8, v9
  v_sub_f32 v89, v89, v8
  v_fma_f32 v89, v89, v128, v8
  v_lshlrev_b32 v8, 16, v103
  v_lshlrev_b32 v9, 16, v119
  v_add_f32 v8, v8, v9
  v_sub_f32 v90, v90, v8
  v_fma_f32 v90, v90, v128, v8
  v_and_b32 v8, 0xffff0000, v103
  v_and_b32 v9, 0xffff0000, v119
  v_add_f32 v8, v8, v9
  v_sub_f32 v91, v91, v8
  v_fma_f32 v91, v91, v128, v8
  v_cvt_pk_bf16_f32 v100, v80, v81
  v_cvt_pk_bf16_f32 v101, v82, v83
  v_cvt_pk_bf16_f32 v102, v88, v89
  v_cvt_pk_bf16_f32 v103, v90, v91
  s_nop 1
  v_permlane16_swap_b32 v100, v102
  v_permlane16_swap_b32 v101, v103
  buffer_store_dwordx4 v[100:103], v130, s[48:51], s99 offen offset:64
  s_add_u32 s99, s59, 0x8000
  v_permlane16_swap_b32 v104, v106
  v_permlane16_swap_b32 v105, v107
  v_permlane16_swap_b32 v120, v122
  v_permlane16_swap_b32 v121, v123
  v_lshlrev_b32 v8, 16, v104
  v_lshlrev_b32 v9, 16, v120
  v_add_f32 v8, v8, v9
  v_sub_f32 v68, v68, v8
  v_fma_f32 v68, v68, v129, v8
  v_and_b32 v8, 0xffff0000, v104
  v_and_b32 v9, 0xffff0000, v120
  v_add_f32 v8, v8, v9
  v_sub_f32 v69, v69, v8
  v_fma_f32 v69, v69, v129, v8
  v_lshlrev_b32 v8, 16, v105
  v_lshlrev_b32 v9, 16, v121
  v_add_f32 v8, v8, v9
  v_sub_f32 v70, v70, v8
  v_fma_f32 v70, v70, v129, v8
  v_and_b32 v8, 0xffff0000, v105
  v_and_b32 v9, 0xffff0000, v121
  v_add_f32 v8, v8, v9
  v_sub_f32 v71, v71, v8
  v_fma_f32 v71, v71, v129, v8
  v_lshlrev_b32 v8, 16, v106
  v_lshlrev_b32 v9, 16, v122
  v_add_f32 v8, v8, v9
  v_sub_f32 v76, v76, v8
  v_fma_f32 v76, v76, v129, v8
  v_and_b32 v8, 0xffff0000, v106
  v_and_b32 v9, 0xffff0000, v122
  v_add_f32 v8, v8, v9
  v_sub_f32 v77, v77, v8
  v_fma_f32 v77, v77, v129, v8
  v_lshlrev_b32 v8, 16, v107
  v_lshlrev_b32 v9, 16, v123
  v_add_f32 v8, v8, v9
  v_sub_f32 v78, v78, v8
  v_fma_f32 v78, v78, v129, v8
  v_and_b32 v8, 0xffff0000, v107
  v_and_b32 v9, 0xffff0000, v123
  v_add_f32 v8, v8, v9
  v_sub_f32 v79, v79, v8
  v_fma_f32 v79, v79, v129, v8
  v_cvt_pk_bf16_f32 v104, v68, v69
  v_cvt_pk_bf16_f32 v105, v70, v71
  v_cvt_pk_bf16_f32 v106, v76, v77
  v_cvt_pk_bf16_f32 v107, v78, v79
  s_nop 1
  v_permlane16_swap_b32 v104, v106
  v_permlane16_swap_b32 v105, v107
  buffer_store_dwordx4 v[104:107], v130, s[48:51], s99 offen offset:0
  v_permlane16_swap_b32 v108, v110
  v_permlane16_swap_b32 v109, v111
  v_permlane16_swap_b32 v124, v126
  v_permlane16_swap_b32 v125, v127
  v_lshlrev_b32 v8, 16, v108
  v_lshlrev_b32 v9, 16, v124
  v_add_f32 v8, v8, v9
  v_sub_f32 v84, v84, v8
  v_fma_f32 v84, v84, v129, v8
  v_and_b32 v8, 0xffff0000, v108
  v_and_b32 v9, 0xffff0000, v124
  v_add_f32 v8, v8, v9
  v_sub_f32 v85, v85, v8
  v_fma_f32 v85, v85, v129, v8
  v_lshlrev_b32 v8, 16, v109
  v_lshlrev_b32 v9, 16, v125
  v_add_f32 v8, v8, v9
  v_sub_f32 v86, v86, v8
  v_fma_f32 v86, v86, v129, v8
  v_and_b32 v8, 0xffff0000, v109
  v_and_b32 v9, 0xffff0000, v125
  v_add_f32 v8, v8, v9
  v_sub_f32 v87, v87, v8
  v_fma_f32 v87, v87, v129, v8
  v_lshlrev_b32 v8, 16, v110
  v_lshlrev_b32 v9, 16, v126
  v_add_f32 v8, v8, v9
  v_sub_f32 v92, v92, v8
  v_fma_f32 v92, v92, v129, v8
  v_and_b32 v8, 0xffff0000, v110
  v_and_b32 v9, 0xffff0000, v126
  v_add_f32 v8, v8, v9
  v_sub_f32 v93, v93, v8
  v_fma_f32 v93, v93, v129, v8
  v_lshlrev_b32 v8, 16, v111
  v_lshlrev_b32 v9, 16, v127
  v_add_f32 v8, v8, v9
  v_sub_f32 v94, v94, v8
  v_fma_f32 v94, v94, v129, v8
  v_and_b32 v8, 0xffff0000, v111
  v_and_b32 v9, 0xffff0000, v127
  v_add_f32 v8, v8, v9
  v_sub_f32 v95, v95, v8
  v_fma_f32 v95, v95, v129, v8
  v_cvt_pk_bf16_f32 v108, v84, v85
  v_cvt_pk_bf16_f32 v109, v86, v87
  v_cvt_pk_bf16_f32 v110, v92, v93
  v_cvt_pk_bf16_f32 v111, v94, v95
  s_nop 1
  v_permlane16_swap_b32 v108, v110
  v_permlane16_swap_b32 v109, v111
  buffer_store_dwordx4 v[108:111], v130, s[48:51], s99 offen offset:64
L_wo_end:
  s_endpgm
.section .rodata,"a"
.p2align 6
.amdhsa_kernel l1_kernel
  .amdhsa_next_free_vgpr 256
  .amdhsa_next_free_sgpr 102
  .amdhsa_accum_offset 256
  .amdhsa_group_segment_fixed_size 0
  .amdhsa_kernarg_size 88
  .amdhsa_user_sgpr_count 2
  .amdhsa_user_sgpr_kernarg_segment_ptr 1
  .amdhsa_system_sgpr_workgroup_id_x 1
.end_amdhsa_kernel

.p2align 6
.amdhsa_kernel mid_kernel
  .amdhsa_next_free_vgpr 144
  .amdhsa_next_free_sgpr 102
  .amdhsa_accum_offset 144
  .amdhsa_group_segment_fixed_size 0
  .amdhsa_kernarg_size 88
  .amdhsa_user_sgpr_count 2
  .amdhsa_user_sgpr_kernarg_segment_ptr 1
  .amdhsa_system_sgpr_workgroup_id_x 1
.end_amdhsa_kernel

.p2align 6
.amdhsa_kernel wo_kernel
  .amdhsa_next_free_vgpr 144
  .amdhsa_next_free_sgpr 102
  .amdhsa_accum_offset 144
  .amdhsa_group_segment_fixed_size 0
  .amdhsa_kernarg_size 88
  .amdhsa_user_sgpr_count 2
  .amdhsa_user_sgpr_kernarg_segment_ptr 1
  .amdhsa_system_sgpr_workgroup_id_x 1
.end_amdhsa_kernel
```
